```python
import torch

def _softmax(x, axis=-1):
    return torch.softmax(x, dim=axis)
def _gelu(x):
    return torch.nn.functional.gelu(x, approximate="tanh")
def _silu(x):
    return torch.nn.functional.silu(x)
def _sigmoid(x):
    return torch.sigmoid(x)
def _layernorm(x, axis=-1, eps=1e-5):
    m = x.mean(dim=axis, keepdim=True)
    v = x.var(dim=axis, keepdim=True, unbiased=False)
    return (x - m) / torch.sqrt(v + eps)
def _scatter_add(tgt, idx, src, axis=0):
    return tgt.clone().index_add_(axis, idx, src)
def _segment_sum(src, seg, n):
    out = torch.zeros((n,) + src.shape[1:], dtype=src.dtype)
    return out.index_add_(0, seg, src)
def _pad(x, pw):
    flat = tuple(v for pair in reversed(pw) for v in pair)
    return torch.nn.functional.pad(x, flat)

kernel_name = 'standalone__kernel_systems_refs_featgraph__graph'

def setup_inputs():

    _w = (lambda a: (lambda t: t.to(torch.bfloat16) if t.is_floating_point() else t)(torch.as_tensor(a)))
    N, deg, D = 25000, 16, 128
    E = N * deg
    scale = D ** -0.5
    src = (lambda lo, hi, *s: torch.randint(lo, hi, s))(0, N, E).to(torch.int64)
    dst = (lambda lo, hi, *s: torch.randint(lo, hi, s))(0, N, E).to(torch.int64)
    return {
        "x": _w((lambda *s: torch.randn(*s, dtype=torch.bfloat16) * 0.8)(N, D)),
        "src": _w(src),
        "dst": _w(dst),
        "w_q": _w((lambda *s: torch.randn(*s, dtype=torch.bfloat16) * 0.8)(D, D) * scale),
        "w_v": _w((lambda *s: torch.randn(*s, dtype=torch.bfloat16) * 0.05)(D, D) * scale),
    }

def reference(x, src, dst, w_q, w_v):
    N, D = x.shape
    xs = x[src]
    xd = x[dst]
    q = xd @ w_q
    logits = torch.einsum('ed,ed->e', xs, q) * (float(D) ** -0.5)
    alpha = _sigmoid(logits)
    msg = alpha[:, None] * (xs @ w_v)
    return _segment_sum(msg, dst, N)
```

```asm
; @launch grid=(256,1,1) block=(512,1,1) lds=154368
.amdgcn_target "amdgcn-amd-amdhsa--gfx950"
.text
.globl standalone__kernel_systems_refs_featgraph__graph_kernel
.p2align 8
.type standalone__kernel_systems_refs_featgraph__graph_kernel,@function
standalone__kernel_systems_refs_featgraph__graph_kernel:
    s_cmp_ge_u32 s2, 256
    s_cbranch_scc1 K_end
    s_load_dwordx4 s[72:75], s[0:1], 48
    s_load_dwordx8 s[60:67], s[0:1], 0
    s_load_dwordx4 s[68:71], s[0:1], 32
    v_lshrrev_b32 v1, 6, v0
    v_and_b32 v2, 63, v0
    v_readfirstlane_b32 s3, v1
    v_lshrrev_b32 v3, 4, v2
    v_and_b32 v4, 15, v2
    v_lshlrev_b32 v201, 4, v0
    v_lshrrev_b32 v9, 3, v0
    s_lshl_b32 s7, s2, 14
    s_add_u32 s37, s7, 8192
    s_mul_i32 s4, s2, 98
    s_mul_i32 s5, s3, 12544
    s_add_u32 s5, s5, 4096
    s_lshl_b32 s6, s3, 12
    s_mul_i32 s76, s2, 12544
    s_add_u32 s77, s76, 8192
    v_lshl_add_u32 v196, v4, 3, s3
    v_lshlrev_b32 v196, 2, v196
    v_xor_b32 v5, v4, v3
    v_lshlrev_b32 v5, 4, v5
    v_lshl_add_u32 v5, v3, 8, v5
    v_add_u32 v28, s6, v5
    s_mul_i32 s38, s3, 4128
    s_add_u32 s38, s38, 104448
    s_lshr_b32 s82, s3, 1
    s_mul_i32 s82, s82, 12544
    s_and_b32 s83, s6, 4096
    s_add_u32 s82, s82, s83
    s_add_u32 s82, s82, 54272
    v_lshlrev_b32 v9, 2, v9
    s_lshl_b32 s89, s2, 2
    s_add_u32 s89, s89, 4194304
    s_mov_b32 s88, 4194304
    s_movk_i32 s36, 272
    v_and_b32 v5, 1, v3
    v_lshrrev_b32 v6, 1, v3
    v_lshl_or_b32 v5, v5, 3, v6
    v_xor_b32 v5, v5, v4
    v_lshlrev_b32 v192, 4, v5
    s_add_u32 s84, s4, s3
    v_lshl_add_u32 v5, v3, 5, s84
    v_xor_b32 v193, 32, v192
    v_xor_b32 v194, 64, v192
    v_xor_b32 v195, 96, v192
    v_lshl_add_u32 v204, v5, 8, v192
    v_add_u32 v5, 8, v5
    v_lshl_add_u32 v205, v5, 8, v193
    v_add_u32 v5, 8, v5
    v_lshl_add_u32 v206, v5, 8, v194
    v_add_u32 v5, 8, v5
    v_lshl_add_u32 v207, v5, 8, v195
    s_cmp_ge_u32 s2, 128
    s_waitcnt lgkmcnt(0)
    s_cbranch_scc1 K_noedge
    s_mov_b32 s32, s64
    s_and_b32 s33, s65, 0xffff
    s_mov_b32 s34, 1600000
    s_mov_b32 s35, 0x00020000
    s_mov_b32 s28, s62
    s_and_b32 s29, s63, 0xffff
    s_mov_b32 s30, 1600000
    s_mov_b32 s31, 0x00020000
    buffer_load_dwordx4 v[96:99], v201, s[32:35], s76 offen
    buffer_load_dwordx4 v[100:103], v201, s[32:35], s77 offen
    buffer_load_dwordx4 v[104:107], v201, s[28:31], s76 offen
    buffer_load_dwordx4 v[108:111], v201, s[28:31], s77 offen
    s_load_dword s58, s[74:75], s89
    s_mov_b32 s12, s74
    s_and_b32 s13, s75, 0xffff
    s_mov_b32 s14, 4194816
    s_mov_b32 s15, 0x00020000
    buffer_load_dword v24, v9, s[12:15], s88 offen
    buffer_load_dword v25, v9, s[12:15], s88 offen offset:256
    s_mov_b32 s20, s66
    s_and_b32 s21, s67, 0xffff
    s_mov_b32 s22, 32768
    s_mov_b32 s23, 0x00020000
    s_mov_b32 s8, s60
    s_and_b32 s9, s61, 0xffff
    s_mov_b32 s10, 6400000
    s_mov_b32 s11, 0x00020000
    s_mov_b32 s24, s68
    s_and_b32 s25, s69, 0xffff
    s_mov_b32 s26, 32768
    s_mov_b32 s27, 0x00020000
    s_branch K_edge
K_noedge:
    s_mov_b32 s20, s66
    s_and_b32 s21, s67, 0xffff
    s_mov_b32 s22, 32768
    s_mov_b32 s23, 0x00020000
    s_mov_b32 s8, s60
    s_and_b32 s9, s61, 0xffff
    s_mov_b32 s10, 6400000
    s_mov_b32 s11, 0x00020000
    s_bfe_u32 s86, s3, 0x10001
    s_lshl3_add_u32 s86, s86, s5
    s_add_u32 m0, s86, 8192
    s_nop 0
    buffer_load_dwordx4 v28, s[20:23], 0 offen offset:0 lds
    buffer_load_dwordx4 v28, s[20:23], 0 offen offset:1024 lds
    buffer_load_dwordx4 v28, s[20:23], 0 offen offset:2048 lds
    buffer_load_dwordx4 v28, s[20:23], 0 offen offset:3072 lds
    s_mov_b32 m0, s82
    s_nop 0
    buffer_load_dwordx4 v204, s[8:11], 0 offen lds
    s_add_u32 m0, m0, 1024
    s_nop 0
    buffer_load_dwordx4 v205, s[8:11], 0 offen lds
    s_add_u32 m0, m0, 1024
    s_nop 0
    buffer_load_dwordx4 v206, s[8:11], 0 offen lds
    s_add_u32 m0, m0, 1024
    s_nop 0
    buffer_load_dwordx4 v207, s[8:11], 0 offen lds
    s_mov_b32 s12, s74
    s_and_b32 s13, s75, 0xffff
    s_mov_b32 s14, 4194816
    s_mov_b32 s15, 0x00020000
    s_mov_b32 s24, s68
    s_and_b32 s25, s69, 0xffff
    s_mov_b32 s26, 32768
    s_mov_b32 s27, 0x00020000
    buffer_load_dword v24, v9, s[12:15], s88 offen
    buffer_load_dword v25, v9, s[12:15], s88 offen offset:256
    s_getreg_b32 s84, hwreg(HW_REG_HW_ID, 13, 2)
    s_getreg_b32 s86, hwreg(HW_REG_HW_ID, 8, 4)
    s_mul_i32 s84, s84, 10
    s_add_u32 s84, s84, s86
    s_mul_i32 s84, s84, 32768
    s_add_u32 s84, s84, 0
    v_lshlrev_b32 v6, 6, v0
    buffer_load_dword v27, v6, s[8:11], s84 offen
    s_mov_b32 s32, s64
    s_and_b32 s33, s65, 0xffff
    s_mov_b32 s34, 1600000
    s_mov_b32 s35, 0x00020000
    s_mov_b32 s28, s62
    s_and_b32 s29, s63, 0xffff
    s_mov_b32 s30, 1600000
    s_mov_b32 s31, 0x00020000
K_edge:
    s_mov_b32 s16, s70
    s_and_b32 s17, s71, 0xffff
    s_mov_b32 s18, 6400000
    s_mov_b32 s19, 0x00020000
    v_mov_b32 v202, 2147418620
    v_mov_b32 v132, v202
    v_mov_b32 v133, v202
    v_mov_b32 v134, v202
    v_mov_b32 v135, v202
    v_add_u32 v6, 137472, v201
    ds_write_b128 v201, v[132:135] offset:4096
    ds_write_b128 v201, v[132:135] offset:16640
    ds_write_b128 v201, v[132:135] offset:29184
    ds_write_b128 v201, v[132:135] offset:41728
    ds_write_b128 v6, v[132:135]
    ds_write_b128 v6, v[132:135] offset:8192
    v_and_b32 v7, 7, v0
    v_lshlrev_b32 v7, 11, v7
    v_bfe_u32 v6, v0, 4, 1
    v_add_u32 v7, 138432, v7
    v_lshlrev_b32 v6, 2, v6
    v_sub_u32 v7, v7, v6
    v_and_b32 v6, 0x108, v0
    v_cmp_eq_u32 vcc, 0x100, v6
    v_lshlrev_b32 v6, 2, v0
    v_mov_b32 v199, 4
    v_cndmask_b32 v7, 0, v7, vcc
    v_cmp_gt_u32 s[56:57], s36, v0
    v_cmp_gt_u32 vcc, 280, v0
    s_mov_b64 exec, vcc
    s_cbranch_execz K_noinit
    ds_write_b32 v6, v7
K_noinit:
    s_mov_b64 exec, -1
    v_and_b32 v5, 7, v4
    v_lshlrev_b32 v5, 1, v5
    v_lshrrev_b32 v6, 3, v4
    v_or_b32 v5, v5, v6
    v_and_b32 v6, 3, v4
    v_lshlrev_b32 v6, 2, v6
    v_lshrrev_b32 v7, 2, v4
    v_or_b32 v6, v6, v7
    v_lshlrev_b32 v7, 2, v3
    v_xor_b32 v7, v7, v5
    v_lshlrev_b32 v7, 4, v7
    v_lshl_add_u32 v7, v6, 8, v7
    v_add_u32 v180, s5, v7
    v_xor_b32 v181, 16, v180
    v_xor_b32 v182, 32, v180
    v_xor_b32 v183, 48, v180
    v_bfe_u32 v6, v2, 2, 2
    v_and_b32 v7, 3, v2
    v_lshl_add_u32 v5, v3, 2, v6
    v_and_b32 v172, 7, v5
    v_lshlrev_b32 v172, 1, v172
    v_lshrrev_b32 v5, 3, v5
    v_or_b32 v5, v5, v172
    v_lshrrev_b32 v172, 1, v7
    v_xor_b32 v5, v5, v172
    v_lshlrev_b32 v5, 4, v5
    v_and_b32 v172, 1, v7
    v_lshl_add_u32 v5, v172, 3, v5
    v_lshl_add_u32 v172, v6, 2, v3
    v_lshl_add_u32 v5, v172, 8, v5
    v_add_u32 v184, s5, v5
    v_xor_b32 v185, 32, v184
    v_xor_b32 v186, 64, v184
    v_xor_b32 v187, 96, v184
    v_xor_b32 v188, 128, v184
    v_xor_b32 v189, 160, v184
    v_xor_b32 v190, 192, v184
    v_xor_b32 v191, 224, v184
    s_lshl_b32 s39, s3, 11
    s_add_u32 s39, s39, 137472
    v_lshl_add_u32 v197, v3, 4, s39
    v_mul_u32_u24 v5, 25088, v3
    v_and_b32 v208, 1, v3
    v_lshl_add_u32 v5, v208, 3, v5
    v_lshl_add_u32 v5, v6, 8, v5
    v_lshl_add_u32 v5, v7, 6, v5
    v_lshl_add_u32 v5, v6, 4, v5
    v_add_u32 v208, 12288, v5
    v_xor_b32 v209, 16, v208
    v_xor_b32 v210, 32, v208
    v_xor_b32 v211, 48, v208
    s_movk_i32 s36, 256
    s_mov_b32 s77, 0
    s_mov_b32 s78, 0x7fff0000
    s_mov_b32 s79, 2147418616
    s_mov_b32 s81, 153856
    s_cmp_ge_u32 s2, 128
    s_cbranch_scc1 K_cons
    s_waitcnt lgkmcnt(0)
    s_barrier
    s_lshr_b32 s76, s76, 2
    v_lshl_add_u32 v1, v0, 2, s76
    s_mov_b32 s84, 400000
    v_cmp_gt_u32 s[90:91], s84, v1
    v_add_u32 v1, 2048, v1
    v_cmp_gt_u32 vcc, s84, v1
    s_movk_i32 s84, -392
    s_movk_i32 s85, 124
    s_and_b64 s[56:57], s[56:57], vcc
    s_or_b32 s58, s58, 0x7fff01fc
    s_add_u32 s58, s58, 1
    s_and_b32 s58, s58, 0x8000fe03
    s_waitcnt vmcnt(4)
    s_mov_b32 m0, s82
    s_nop 0
    buffer_load_dwordx4 v204, s[8:11], 0 offen lds
    s_add_u32 m0, m0, 1024
    s_nop 0
    buffer_load_dwordx4 v205, s[8:11], 0 offen lds
    s_add_u32 m0, m0, 1024
    s_nop 0
    buffer_load_dwordx4 v206, s[8:11], 0 offen lds
    s_add_u32 m0, m0, 1024
    s_nop 0
    buffer_load_dwordx4 v207, s[8:11], 0 offen lds
    s_mov_b64 exec, s[90:91]
    v_mul_u32_u24 v112, 21400, v96
    v_lshrrev_b32 v112, 21, v112
    v_lshlrev_b32 v5, 2, v112
    ds_add_rtn_u32 v120, v5, v199 offset:0
    v_lshlrev_b32 v96, 2, v96
    v_mad_i32_i24 v96, v112, s84, v96
    v_lshrrev_b32 v5, 6, v112
    v_mad_u32_u24 v112, v5, 34, v112
    v_mul_u32_u24 v113, 21400, v97
    v_lshrrev_b32 v113, 21, v113
    v_lshlrev_b32 v5, 2, v113
    ds_add_rtn_u32 v121, v5, v199 offset:0
    v_lshlrev_b32 v97, 2, v97
    v_mad_i32_i24 v97, v113, s84, v97
    v_lshrrev_b32 v5, 6, v113
    v_mad_u32_u24 v113, v5, 34, v113
    v_mul_u32_u24 v114, 21400, v98
    v_lshrrev_b32 v114, 21, v114
    v_lshlrev_b32 v5, 2, v114
    ds_add_rtn_u32 v122, v5, v199 offset:0
    v_lshlrev_b32 v98, 2, v98
    v_mad_i32_i24 v98, v114, s84, v98
    v_lshrrev_b32 v5, 6, v114
    v_mad_u32_u24 v114, v5, 34, v114
    v_mul_u32_u24 v115, 21400, v99
    v_lshrrev_b32 v115, 21, v115
    v_lshlrev_b32 v5, 2, v115
    ds_add_rtn_u32 v123, v5, v199 offset:0
    v_lshlrev_b32 v99, 2, v99
    v_mad_i32_i24 v99, v115, s84, v99
    v_lshrrev_b32 v5, 6, v115
    v_mad_u32_u24 v115, v5, 34, v115
    s_mov_b64 exec, s[56:57]
    s_cbranch_execz K_noB1
    v_mul_u32_u24 v116, 21400, v100
    v_lshrrev_b32 v116, 21, v116
    v_lshlrev_b32 v5, 2, v116
    ds_add_rtn_u32 v124, v5, v199 offset:0
    v_lshlrev_b32 v100, 2, v100
    v_mad_i32_i24 v100, v116, s84, v100
    v_lshrrev_b32 v5, 6, v116
    v_mad_u32_u24 v116, v5, 34, v116
    v_mul_u32_u24 v117, 21400, v101
    v_lshrrev_b32 v117, 21, v117
    v_lshlrev_b32 v5, 2, v117
    ds_add_rtn_u32 v125, v5, v199 offset:0
    v_lshlrev_b32 v101, 2, v101
    v_mad_i32_i24 v101, v117, s84, v101
    v_lshrrev_b32 v5, 6, v117
    v_mad_u32_u24 v117, v5, 34, v117
    v_mul_u32_u24 v118, 21400, v102
    v_lshrrev_b32 v118, 21, v118
    v_lshlrev_b32 v5, 2, v118
    ds_add_rtn_u32 v126, v5, v199 offset:0
    v_lshlrev_b32 v102, 2, v102
    v_mad_i32_i24 v102, v118, s84, v102
    v_lshrrev_b32 v5, 6, v118
    v_mad_u32_u24 v118, v5, 34, v118
    v_mul_u32_u24 v119, 21400, v103
    v_lshrrev_b32 v119, 21, v119
    v_lshlrev_b32 v5, 2, v119
    ds_add_rtn_u32 v127, v5, v199 offset:0
    v_lshlrev_b32 v103, 2, v103
    v_mad_i32_i24 v103, v119, s84, v103
    v_lshrrev_b32 v5, 6, v119
    v_mad_u32_u24 v119, v5, 34, v119
K_noB1:
    s_waitcnt vmcnt(6)
    s_cbranch_execz K_noB2
    v_lshl_or_b32 v100, v108, 16, v100
    s_waitcnt lgkmcnt(3)
    v_min_u32 v124, s85, v124
    v_lshl_add_u32 v124, v116, 7, v124
    ds_write_b32 v124, v100 offset:4096
    v_lshl_or_b32 v101, v109, 16, v101
    s_waitcnt lgkmcnt(3)
    v_min_u32 v125, s85, v125
    v_lshl_add_u32 v125, v117, 7, v125
    ds_write_b32 v125, v101 offset:4096
    v_lshl_or_b32 v102, v110, 16, v102
    s_waitcnt lgkmcnt(3)
    v_min_u32 v126, s85, v126
    v_lshl_add_u32 v126, v118, 7, v126
    ds_write_b32 v126, v102 offset:4096
    v_lshl_or_b32 v103, v111, 16, v103
    s_waitcnt lgkmcnt(3)
    v_min_u32 v127, s85, v127
    v_lshl_add_u32 v127, v119, 7, v127
    ds_write_b32 v127, v103 offset:4096
K_noB2:
    s_mov_b64 exec, s[90:91]
    v_lshl_or_b32 v96, v104, 16, v96
    s_waitcnt lgkmcnt(3)
    v_min_u32 v120, s85, v120
    v_lshl_add_u32 v120, v112, 7, v120
    ds_write_b32 v120, v96 offset:4096
    v_lshl_or_b32 v97, v105, 16, v97
    s_waitcnt lgkmcnt(3)
    v_min_u32 v121, s85, v121
    v_lshl_add_u32 v121, v113, 7, v121
    ds_write_b32 v121, v97 offset:4096
    v_lshl_or_b32 v98, v106, 16, v98
    s_waitcnt lgkmcnt(3)
    v_min_u32 v122, s85, v122
    v_lshl_add_u32 v122, v114, 7, v122
    ds_write_b32 v122, v98 offset:4096
    v_lshl_or_b32 v99, v107, 16, v99
    s_waitcnt lgkmcnt(3)
    v_min_u32 v123, s85, v123
    v_lshl_add_u32 v123, v115, 7, v123
    ds_write_b32 v123, v99 offset:4096
    s_mov_b64 exec, -1
    v_lshrrev_b32 v5, 3, v0
    v_and_b32 v6, 7, v0
    v_lshlrev_b32 v3, 2, v5
    v_lshlrev_b32 v5, 14, v5
    v_lshl_add_u32 v4, v6, 4, v5
    s_lshl_b32 s84, s2, 7
    s_bfe_u32 s86, s3, 0x10001
    s_lshl3_add_u32 s86, s86, s5
    s_add_u32 m0, s86, 8192
    s_nop 0
    buffer_load_dwordx4 v28, s[20:23], 0 offen offset:0 lds
    buffer_load_dwordx4 v28, s[20:23], 0 offen offset:1024 lds
    buffer_load_dwordx4 v28, s[20:23], 0 offen offset:2048 lds
    buffer_load_dwordx4 v28, s[20:23], 0 offen offset:3072 lds
    s_waitcnt lgkmcnt(0)
    s_barrier
    ds_read_b32 v16, v3 offset:0
    ds_read_b32 v17, v3 offset:256
    ds_read_b32 v18, v3 offset:512
    ds_read_b32 v19, v3 offset:768
    ds_read_b128 v[136:139], v201 offset:4096
    ds_read_b128 v[140:143], v201 offset:16640
    ds_read_b128 v[144:147], v201 offset:29184
    ds_read_b128 v[148:151], v201 offset:41728
    s_movk_i32 s85, 128
    s_waitcnt lgkmcnt(4)
    v_max3_u32 v5, v16, v17, v18
    v_max_u32 v5, v5, v19
    v_cmp_lt_u32 vcc, s85, v5
    s_cbranch_vccz K_noovf
    v_cmp_eq_u32 vcc, 0, v6
    v_mov_b32 v5, s79
    s_waitcnt lgkmcnt(0)
    v_cndmask_b32 v5, v202, v5, vcc
    v_cmp_lt_u32 vcc, s85, v16
    s_nop 1
    v_cndmask_b32 v136, v136, v5, vcc
    v_cndmask_b32 v137, v137, v202, vcc
    v_cndmask_b32 v138, v138, v202, vcc
    v_cndmask_b32 v139, v139, v202, vcc
    v_cmp_lt_u32 vcc, s85, v17
    s_nop 1
    v_cndmask_b32 v140, v140, v5, vcc
    v_cndmask_b32 v141, v141, v202, vcc
    v_cndmask_b32 v142, v142, v202, vcc
    v_cndmask_b32 v143, v143, v202, vcc
    v_cmp_lt_u32 vcc, s85, v18
    s_nop 1
    v_cndmask_b32 v144, v144, v5, vcc
    v_cndmask_b32 v145, v145, v202, vcc
    v_cndmask_b32 v146, v146, v202, vcc
    v_cndmask_b32 v147, v147, v202, vcc
    v_cmp_lt_u32 vcc, s85, v19
    s_nop 1
    v_cndmask_b32 v148, v148, v5, vcc
    v_cndmask_b32 v149, v149, v202, vcc
    v_cndmask_b32 v150, v150, v202, vcc
    v_cndmask_b32 v151, v151, v202, vcc
K_noovf:
    s_waitcnt lgkmcnt(3)
    v_xor_b32 v136, s58, v136
    v_xor_b32 v137, s58, v137
    v_xor_b32 v138, s58, v138
    v_xor_b32 v139, s58, v139
    buffer_store_dwordx4 v[136:139], v4, s[12:15], s84 offen sc1
    s_add_u32 s84, s84, 1048576
    s_waitcnt lgkmcnt(2)
    v_xor_b32 v140, s58, v140
    v_xor_b32 v141, s58, v141
    v_xor_b32 v142, s58, v142
    v_xor_b32 v143, s58, v143
    buffer_store_dwordx4 v[140:143], v4, s[12:15], s84 offen sc1
    s_add_u32 s84, s84, 1048576
    s_waitcnt lgkmcnt(1)
    v_xor_b32 v144, s58, v144
    v_xor_b32 v145, s58, v145
    v_xor_b32 v146, s58, v146
    v_xor_b32 v147, s58, v147
    buffer_store_dwordx4 v[144:147], v4, s[12:15], s84 offen sc1
    s_add_u32 s84, s84, 1048576
    s_waitcnt lgkmcnt(0)
    v_xor_b32 v148, s58, v148
    v_xor_b32 v149, s58, v149
    v_xor_b32 v150, s58, v150
    v_xor_b32 v151, s58, v151
    buffer_store_dwordx4 v[148:151], v4, s[12:15], s84 offen sc1
    s_waitcnt vmcnt(4)
    s_barrier
    s_branch K_q
K_cons:
    s_waitcnt vmcnt(1) lgkmcnt(0)
    s_barrier
    s_mov_b32 m0, s38
    s_nop 0
    buffer_load_dwordx4 v28, s[24:27], 0 offen offset:0 lds
    s_add_u32 m0, m0, 8
    s_nop 0
    buffer_load_dwordx4 v28, s[24:27], 0 offen offset:1024 lds
    s_add_u32 m0, m0, 8
    s_nop 0
    buffer_load_dwordx4 v28, s[24:27], 0 offen offset:2048 lds
    s_add_u32 m0, m0, 8
    s_nop 0
    buffer_load_dwordx4 v28, s[24:27], 0 offen offset:3072 lds
K_q:
    s_sub_u32 s84, s82, s5
    v_add_u32 v4, s84, v180
    v_xor_b32 v5, 16, v4
    v_xor_b32 v6, 32, v4
    v_xor_b32 v7, 48, v4
    ds_read_b128 v[212:215], v4
    ds_read_b128 v[216:219], v5
    ds_read_b128 v[220:223], v6
    ds_read_b128 v[224:227], v7
    ds_read_b64_tr_b16 v[96:97], v208 offset:0
    ds_read_b64_tr_b16 v[98:99], v208 offset:1024
    ds_read_b64_tr_b16 v[100:101], v208 offset:2048
    ds_read_b64_tr_b16 v[102:103], v208 offset:3072
    ds_read_b64_tr_b16 v[104:105], v208 offset:12544
    ds_read_b64_tr_b16 v[106:107], v208 offset:13568
    ds_read_b64_tr_b16 v[108:109], v208 offset:14592
    ds_read_b64_tr_b16 v[110:111], v208 offset:15616
    ds_read_b64_tr_b16 v[112:113], v208 offset:8
    ds_read_b64_tr_b16 v[114:115], v208 offset:1032
    ds_read_b64_tr_b16 v[116:117], v208 offset:2056
    ds_read_b64_tr_b16 v[118:119], v208 offset:3080
    ds_read_b64_tr_b16 v[120:121], v208 offset:12552
    ds_read_b64_tr_b16 v[122:123], v208 offset:13576
    ds_read_b64_tr_b16 v[124:125], v208 offset:14600
    ds_read_b64_tr_b16 v[126:127], v208 offset:15624
    ds_read_b64_tr_b16 v[128:129], v209 offset:0
    ds_read_b64_tr_b16 v[130:131], v209 offset:1024
    ds_read_b64_tr_b16 v[132:133], v209 offset:2048
    ds_read_b64_tr_b16 v[134:135], v209 offset:3072
    ds_read_b64_tr_b16 v[136:137], v209 offset:12544
    ds_read_b64_tr_b16 v[138:139], v209 offset:13568
    ds_read_b64_tr_b16 v[140:141], v209 offset:14592
    ds_read_b64_tr_b16 v[142:143], v209 offset:15616
    ds_read_b64_tr_b16 v[144:145], v209 offset:8
    ds_read_b64_tr_b16 v[146:147], v209 offset:1032
    ds_read_b64_tr_b16 v[148:149], v209 offset:2056
    ds_read_b64_tr_b16 v[150:151], v209 offset:3080
    ds_read_b64_tr_b16 v[152:153], v209 offset:12552
    ds_read_b64_tr_b16 v[154:155], v209 offset:13576
    ds_read_b64_tr_b16 v[156:157], v209 offset:14600
    ds_read_b64_tr_b16 v[158:159], v209 offset:15624
    s_waitcnt lgkmcnt(15)
    v_mfma_f32_16x16x32_bf16 v[64:67], v[96:99], v[212:215], 0
    v_mfma_f32_16x16x32_bf16 v[68:71], v[112:115], v[212:215], 0
    v_mfma_f32_16x16x32_bf16 v[64:67], v[100:103], v[216:219], v[64:67]
    v_mfma_f32_16x16x32_bf16 v[68:71], v[116:119], v[216:219], v[68:71]
    v_mfma_f32_16x16x32_bf16 v[64:67], v[104:107], v[220:223], v[64:67]
    v_mfma_f32_16x16x32_bf16 v[68:71], v[120:123], v[220:223], v[68:71]
    v_mfma_f32_16x16x32_bf16 v[64:67], v[108:111], v[224:227], v[64:67]
    v_mfma_f32_16x16x32_bf16 v[68:71], v[124:127], v[224:227], v[68:71]
    ds_read_b64_tr_b16 v[96:97], v210 offset:0
    ds_read_b64_tr_b16 v[98:99], v210 offset:1024
    ds_read_b64_tr_b16 v[100:101], v210 offset:2048
    ds_read_b64_tr_b16 v[102:103], v210 offset:3072
    ds_read_b64_tr_b16 v[104:105], v210 offset:12544
    ds_read_b64_tr_b16 v[106:107], v210 offset:13568
    ds_read_b64_tr_b16 v[108:109], v210 offset:14592
    ds_read_b64_tr_b16 v[110:111], v210 offset:15616
    ds_read_b64_tr_b16 v[112:113], v210 offset:8
    ds_read_b64_tr_b16 v[114:115], v210 offset:1032
    ds_read_b64_tr_b16 v[116:117], v210 offset:2056
    ds_read_b64_tr_b16 v[118:119], v210 offset:3080
    ds_read_b64_tr_b16 v[120:121], v210 offset:12552
    ds_read_b64_tr_b16 v[122:123], v210 offset:13576
    ds_read_b64_tr_b16 v[124:125], v210 offset:14600
    ds_read_b64_tr_b16 v[126:127], v210 offset:15624
    s_waitcnt lgkmcnt(15)
    v_mfma_f32_16x16x32_bf16 v[72:75], v[128:131], v[212:215], 0
    v_mfma_f32_16x16x32_bf16 v[76:79], v[144:147], v[212:215], 0
    v_mfma_f32_16x16x32_bf16 v[72:75], v[132:135], v[216:219], v[72:75]
    v_mfma_f32_16x16x32_bf16 v[76:79], v[148:151], v[216:219], v[76:79]
    v_mfma_f32_16x16x32_bf16 v[72:75], v[136:139], v[220:223], v[72:75]
    v_mfma_f32_16x16x32_bf16 v[76:79], v[152:155], v[220:223], v[76:79]
    v_mfma_f32_16x16x32_bf16 v[72:75], v[140:143], v[224:227], v[72:75]
    v_mfma_f32_16x16x32_bf16 v[76:79], v[156:159], v[224:227], v[76:79]
    ds_read_b64_tr_b16 v[128:129], v211 offset:0
    ds_read_b64_tr_b16 v[130:131], v211 offset:1024
    ds_read_b64_tr_b16 v[132:133], v211 offset:2048
    ds_read_b64_tr_b16 v[134:135], v211 offset:3072
    ds_read_b64_tr_b16 v[136:137], v211 offset:12544
    ds_read_b64_tr_b16 v[138:139], v211 offset:13568
    ds_read_b64_tr_b16 v[140:141], v211 offset:14592
    ds_read_b64_tr_b16 v[142:143], v211 offset:15616
    ds_read_b64_tr_b16 v[144:145], v211 offset:8
    ds_read_b64_tr_b16 v[146:147], v211 offset:1032
    ds_read_b64_tr_b16 v[148:149], v211 offset:2056
    ds_read_b64_tr_b16 v[150:151], v211 offset:3080
    ds_read_b64_tr_b16 v[152:153], v211 offset:12552
    ds_read_b64_tr_b16 v[154:155], v211 offset:13576
    ds_read_b64_tr_b16 v[156:157], v211 offset:14600
    ds_read_b64_tr_b16 v[158:159], v211 offset:15624
    s_waitcnt lgkmcnt(15)
    v_mfma_f32_16x16x32_bf16 v[80:83], v[96:99], v[212:215], 0
    v_mfma_f32_16x16x32_bf16 v[84:87], v[112:115], v[212:215], 0
    v_mfma_f32_16x16x32_bf16 v[80:83], v[100:103], v[216:219], v[80:83]
    v_mfma_f32_16x16x32_bf16 v[84:87], v[116:119], v[216:219], v[84:87]
    v_mfma_f32_16x16x32_bf16 v[80:83], v[104:107], v[220:223], v[80:83]
    v_mfma_f32_16x16x32_bf16 v[84:87], v[120:123], v[220:223], v[84:87]
    v_mfma_f32_16x16x32_bf16 v[80:83], v[108:111], v[224:227], v[80:83]
    v_mfma_f32_16x16x32_bf16 v[84:87], v[124:127], v[224:227], v[84:87]
    s_waitcnt lgkmcnt(0)
    buffer_load_dwordx4 v[8:11], v201, s[12:15], s7 offen sc1
    buffer_load_dwordx4 v[12:15], v201, s[12:15], s37 offen sc1
    s_cmp_ge_u32 s2, 128
    s_cbranch_scc1 K_nowv
    s_mov_b32 m0, s38
    s_nop 0
    buffer_load_dwordx4 v28, s[24:27], 0 offen offset:0 lds
    s_add_u32 m0, m0, 8
    s_nop 0
    buffer_load_dwordx4 v28, s[24:27], 0 offen offset:1024 lds
    s_add_u32 m0, m0, 8
    s_nop 0
    buffer_load_dwordx4 v28, s[24:27], 0 offen offset:2048 lds
    s_add_u32 m0, m0, 8
    s_nop 0
    buffer_load_dwordx4 v28, s[24:27], 0 offen offset:3072 lds
K_nowv:
    v_mfma_f32_16x16x32_bf16 v[88:91], v[128:131], v[212:215], 0
    v_mfma_f32_16x16x32_bf16 v[92:95], v[144:147], v[212:215], 0
    v_mfma_f32_16x16x32_bf16 v[88:91], v[132:135], v[216:219], v[88:91]
    v_mfma_f32_16x16x32_bf16 v[92:95], v[148:151], v[216:219], v[92:95]
    v_mfma_f32_16x16x32_bf16 v[88:91], v[136:139], v[220:223], v[88:91]
    v_mfma_f32_16x16x32_bf16 v[92:95], v[152:155], v[220:223], v[92:95]
    v_mfma_f32_16x16x32_bf16 v[88:91], v[140:143], v[224:227], v[88:91]
    v_mfma_f32_16x16x32_bf16 v[92:95], v[156:159], v[224:227], v[92:95]
    s_mov_b32 s87, 0x8000fe03
    s_movk_i32 s59, 400
    v_or_b32 v24, 0x7fff01fc, v24
    v_add_u32 v24, 1, v24
    v_and_b32 v24, s87, v24
    v_or_b32 v25, 0x7fff01fc, v25
    v_add_u32 v25, 1, v25
    v_and_b32 v25, s87, v25
    s_mov_b32 s90, 0xbe0293ee
    s_mov_b32 s91, s90
    s_nop 2
    v_pk_mul_f32 v[64:65], v[64:65], s[90:91]
    v_pk_mul_f32 v[66:67], v[66:67], s[90:91]
    v_pk_mul_f32 v[68:69], v[68:69], s[90:91]
    v_pk_mul_f32 v[70:71], v[70:71], s[90:91]
    v_pk_mul_f32 v[72:73], v[72:73], s[90:91]
    v_pk_mul_f32 v[74:75], v[74:75], s[90:91]
    v_pk_mul_f32 v[76:77], v[76:77], s[90:91]
    v_pk_mul_f32 v[78:79], v[78:79], s[90:91]
    v_pk_mul_f32 v[80:81], v[80:81], s[90:91]
    v_pk_mul_f32 v[82:83], v[82:83], s[90:91]
    v_pk_mul_f32 v[84:85], v[84:85], s[90:91]
    v_pk_mul_f32 v[86:87], v[86:87], s[90:91]
    v_pk_mul_f32 v[88:89], v[88:89], s[90:91]
    v_pk_mul_f32 v[90:91], v[90:91], s[90:91]
    v_pk_mul_f32 v[92:93], v[92:93], s[90:91]
    v_pk_mul_f32 v[94:95], v[94:95], s[90:91]
    v_cvt_pk_bf16_f32 v48, v64, v65
    v_cvt_pk_bf16_f32 v49, v66, v67
    v_cvt_pk_bf16_f32 v50, v68, v69
    v_cvt_pk_bf16_f32 v51, v70, v71
    v_cvt_pk_bf16_f32 v52, v72, v73
    v_cvt_pk_bf16_f32 v53, v74, v75
    v_cvt_pk_bf16_f32 v54, v76, v77
    v_cvt_pk_bf16_f32 v55, v78, v79
    v_cvt_pk_bf16_f32 v56, v80, v81
    v_cvt_pk_bf16_f32 v57, v82, v83
    v_cvt_pk_bf16_f32 v58, v84, v85
    v_cvt_pk_bf16_f32 v59, v86, v87
    v_cvt_pk_bf16_f32 v60, v88, v89
    v_cvt_pk_bf16_f32 v61, v90, v91
    v_cvt_pk_bf16_f32 v62, v92, v93
    v_cvt_pk_bf16_f32 v63, v94, v95
    v_mov_b64 v[64:65], 0
    v_mov_b64 v[66:67], 0
    v_mov_b64 v[68:69], 0
    v_mov_b64 v[70:71], 0
    v_mov_b64 v[72:73], 0
    v_mov_b64 v[74:75], 0
    v_mov_b64 v[76:77], 0
    v_mov_b64 v[78:79], 0
    v_mov_b64 v[80:81], 0
    v_mov_b64 v[82:83], 0
    v_mov_b64 v[84:85], 0
    v_mov_b64 v[86:87], 0
    v_mov_b64 v[88:89], 0
    v_mov_b64 v[90:91], 0
    v_mov_b64 v[92:93], 0
    v_mov_b64 v[94:95], 0
    s_cmp_ge_u32 s2, 128
    s_cbranch_scc1 K_pollw
    s_waitcnt vmcnt(4)
    s_branch K_pollc
K_poll:
    buffer_load_dwordx4 v[8:11], v201, s[12:15], s7 offen sc1
    buffer_load_dwordx4 v[12:15], v201, s[12:15], s37 offen sc1
K_pollw:
    s_waitcnt vmcnt(0)
K_pollc:
    v_xor_b32 v8, v24, v8
    v_xor_b32 v9, v24, v9
    v_xor_b32 v10, v24, v10
    v_xor_b32 v11, v24, v11
    v_xor_b32 v12, v25, v12
    v_xor_b32 v13, v25, v13
    v_xor_b32 v14, v25, v14
    v_xor_b32 v15, v25, v15
    v_or3_b32 v5, v8, v9, v10
    v_or3_b32 v6, v11, v12, v13
    v_or3_b32 v5, v5, v14, v15
    v_or_b32 v5, v5, v6
    v_and_b32 v5, s87, v5
    v_cmpx_ne_u32 vcc, 0, v5
    s_cbranch_execz K_pollok
    s_sub_u32 s59, s59, 1
    s_cbranch_scc0 K_poll
    s_mov_b64 exec, -1
    v_and_b32 v7, 56, v0
    v_and_b32 v6, 7, v0
    v_cmp_eq_u32 vcc, 0, v6
    v_mov_b32 v6, s79
    s_nop 0
    v_cndmask_b32 v6, v202, v6, vcc
    v_or3_b32 v5, v8, v9, v10
    v_or_b32 v5, v5, v11
    v_and_b32 v5, s87, v5
    v_cmp_ne_u32 vcc, 0, v5
    s_nop 4
    v_lshrrev_b64 v[2:3], v7, vcc
    v_and_b32 v2, 0xff, v2
    v_cmp_ne_u32 vcc, 0, v2
    s_nop 1
    v_cndmask_b32 v8, v8, v6, vcc
    v_cndmask_b32 v9, v9, v202, vcc
    v_cndmask_b32 v10, v10, v202, vcc
    v_cndmask_b32 v11, v11, v202, vcc
    v_or3_b32 v5, v12, v13, v14
    v_or_b32 v5, v5, v15
    v_and_b32 v5, s87, v5
    v_cmp_ne_u32 vcc, 0, v5
    s_nop 4
    v_lshrrev_b64 v[2:3], v7, vcc
    v_and_b32 v2, 0xff, v2
    v_cmp_ne_u32 vcc, 0, v2
    s_nop 1
    v_cndmask_b32 v12, v12, v6, vcc
    v_cndmask_b32 v13, v13, v202, vcc
    v_cndmask_b32 v14, v14, v202, vcc
    v_cndmask_b32 v15, v15, v202, vcc
K_pollok:
    s_mov_b64 exec, -1
    s_getreg_b32 s84, hwreg(HW_REG_HW_ID, 13, 2)
    s_getreg_b32 s86, hwreg(HW_REG_HW_ID, 8, 4)
    s_mul_i32 s84, s84, 10
    s_add_u32 s84, s84, s86
    s_mul_i32 s84, s84, 32768
    s_add_u32 s84, s84, 1310720
    v_lshlrev_b32 v6, 6, v0
    buffer_load_dword v244, v6, s[8:11], s84 offen
    s_mov_b32 s84, 805306368
    v_mov_b32 v168, 137472
    v_subrev_u32 v160, s84, v8
    v_and_b32 v172, 28, v8
    v_subrev_u32 v161, s84, v9
    v_and_b32 v173, 28, v9
    v_subrev_u32 v162, s84, v10
    v_and_b32 v174, 28, v10
    v_subrev_u32 v163, s84, v11
    v_and_b32 v175, 28, v11
    v_subrev_u32 v164, s84, v12
    v_and_b32 v176, 28, v12
    v_subrev_u32 v165, s84, v13
    v_and_b32 v177, 28, v13
    v_subrev_u32 v166, s84, v14
    v_and_b32 v178, 28, v14
    v_subrev_u32 v167, s84, v15
    v_and_b32 v179, 28, v15
    v_ashrrev_i32 v160, 31, v160
    v_and_or_b32 v172, v160, 64, v172
    v_and_or_b32 v160, v160, -8, v199
    v_cmpx_gt_u32 s[40:41], s78, v8
    ds_add_rtn_u32 v16, v172, v160 offset:1024
    v_ashrrev_i32 v161, 31, v161
    v_and_or_b32 v173, v161, 64, v173
    v_and_or_b32 v161, v161, -8, v199
    v_cmpx_gt_u32 s[42:43], s78, v9
    ds_add_rtn_u32 v17, v173, v161 offset:1024
    v_ashrrev_i32 v162, 31, v162
    v_and_or_b32 v174, v162, 64, v174
    v_and_or_b32 v162, v162, -8, v199
    v_cmpx_gt_u32 s[44:45], s78, v10
    ds_add_rtn_u32 v18, v174, v162 offset:1024
    v_ashrrev_i32 v163, 31, v163
    v_and_or_b32 v175, v163, 64, v175
    v_and_or_b32 v163, v163, -8, v199
    v_cmpx_gt_u32 s[46:47], s78, v11
    ds_add_rtn_u32 v19, v175, v163 offset:1024
    s_mov_b64 exec, -1
    v_ashrrev_i32 v164, 31, v164
    v_and_or_b32 v176, v164, 64, v176
    v_and_or_b32 v164, v164, -8, v199
    v_cmpx_gt_u32 s[48:49], s78, v12
    ds_add_rtn_u32 v20, v176, v164 offset:1024
    v_ashrrev_i32 v165, 31, v165
    v_and_or_b32 v177, v165, 64, v177
    v_and_or_b32 v165, v165, -8, v199
    v_cmpx_gt_u32 s[50:51], s78, v13
    ds_add_rtn_u32 v21, v177, v165 offset:1024
    v_ashrrev_i32 v166, 31, v166
    v_and_or_b32 v178, v166, 64, v178
    v_and_or_b32 v166, v166, -8, v199
    v_cmpx_gt_u32 s[52:53], s78, v14
    ds_add_rtn_u32 v22, v178, v166 offset:1024
    v_ashrrev_i32 v167, 31, v167
    v_and_or_b32 v179, v167, 64, v179
    v_and_or_b32 v167, v167, -8, v199
    v_cmpx_gt_u32 s[54:55], s78, v15
    ds_add_rtn_u32 v23, v179, v167 offset:1024
    s_mov_b64 exec, -1
    v_cmp_eq_u32 vcc, s79, v8
    v_cmp_eq_u32 s[56:57], s79, v12
    v_and_b32 v5, 31, v0
    v_and_b32 v6, 7, v0
    s_or_b64 s[56:57], s[56:57], vcc
    s_cbranch_scc0 K_nomark
    s_waitcnt lgkmcnt(0)
    v_lshrrev_b32 v4, 3, v0
    v_mov_b32 v3, 1056
    v_cmpx_eq_u32 vcc, s79, v8
    ds_add_rtn_u32 v7, v3, v199
    v_add_u32 v1, 0, v4
    s_waitcnt lgkmcnt(0)
    ds_write_b32 v7, v1 offset:1152
    s_mov_b64 exec, -1
    v_cmpx_eq_u32 vcc, s79, v12
    ds_add_rtn_u32 v7, v3, v199
    v_add_u32 v1, 64, v4
    s_waitcnt lgkmcnt(0)
    ds_write_b32 v7, v1 offset:1152
    s_mov_b64 exec, -1
    s_waitcnt lgkmcnt(0)
K_nomark:
    s_mov_b64 exec, s[40:41]
    s_waitcnt lgkmcnt(7)
    v_med3_u32 v16, v16, s81, v168
    ds_write_b32 v16, v8
    s_mov_b64 exec, s[42:43]
    s_waitcnt lgkmcnt(7)
    v_med3_u32 v17, v17, s81, v168
    ds_write_b32 v17, v9
    s_mov_b64 exec, s[44:45]
    s_waitcnt lgkmcnt(7)
    v_med3_u32 v18, v18, s81, v168
    ds_write_b32 v18, v10
    s_mov_b64 exec, s[46:47]
    s_waitcnt lgkmcnt(7)
    v_med3_u32 v19, v19, s81, v168
    ds_write_b32 v19, v11
    s_mov_b64 exec, s[48:49]
    s_waitcnt lgkmcnt(7)
    v_med3_u32 v20, v20, s81, v168
    ds_write_b32 v20, v12
    s_mov_b64 exec, s[50:51]
    s_waitcnt lgkmcnt(7)
    v_med3_u32 v21, v21, s81, v168
    ds_write_b32 v21, v13
    s_mov_b64 exec, s[52:53]
    s_waitcnt lgkmcnt(7)
    v_med3_u32 v22, v22, s81, v168
    ds_write_b32 v22, v14
    s_mov_b64 exec, s[54:55]
    s_waitcnt lgkmcnt(7)
    v_med3_u32 v23, v23, s81, v168
    ds_write_b32 v23, v15
    s_mov_b64 exec, -1
    v_lshlrev_b32 v5, 2, v5
    v_lshlrev_b32 v6, 11, v6
    v_add_u32 v6, 138430, v6
    s_mov_b32 s80, 0
    s_mov_b32 s83, 0
    s_movk_i32 s84, 962
    s_add_u32 s86, s3, 16
    v_subrev_u32 v200, s39, v197
    s_waitcnt vmcnt(1) lgkmcnt(0)
    s_barrier
    ds_read_b32 v5, v5 offset:1024
    s_waitcnt lgkmcnt(0)
    v_sad_u32 v6, v5, v6, 0
    v_readlane_b32 s86, v5, s86
    v_readlane_b32 s82, v5, s3
    v_cmp_lt_u32 vcc, s84, v6
    s_add_u32 s86, s86, 4
    s_and_b32 s86, s86, -16
    v_readlane_b32 s85, v5, 8
    v_add_u32 v200, s86, v200
    s_and_b32 s84, vcc_lo, 0xff00ff
    s_cbranch_scc1 K_geninit
    ds_read_b128 v[24:27], v200
    ds_read_b128 v[28:31], v200 offset:64
    ds_read_b128 v[32:35], v200 offset:128
    s_sub_u32 s84, s82, s86
    s_add_u32 s84, s84, 124
    s_lshr_b32 s86, s84, 7
K_listrdy:
    s_setprio 3
    s_cmp_eq_u32 s86, 0
    s_cbranch_scc1 K_pre
    s_waitcnt lgkmcnt(1)
    s_add_u32 m0, s5, 0
    v_mad_u32_u16 v172, v24, s36, v192 op_sel:[1,0,0,0]
    v_mad_u32_u16 v173, v25, s36, v193 op_sel:[1,0,0,0]
    v_mad_u32_u16 v174, v26, s36, v194 op_sel:[1,0,0,0]
    v_mad_u32_u16 v175, v27, s36, v195 op_sel:[1,0,0,0]
    buffer_load_dwordx4 v172, s[8:11], 0 offen lds
    s_add_u32 m0, m0, 1024
    s_nop 0
    buffer_load_dwordx4 v173, s[8:11], 0 offen lds
    s_add_u32 m0, m0, 1024
    s_nop 0
    buffer_load_dwordx4 v174, s[8:11], 0 offen lds
    s_add_u32 m0, m0, 1024
    s_nop 0
    buffer_load_dwordx4 v175, s[8:11], 0 offen lds
    s_add_u32 m0, s5, 4096
    v_mad_u32_u16 v172, v28, s36, v192 op_sel:[1,0,0,0]
    v_mad_u32_u16 v173, v29, s36, v193 op_sel:[1,0,0,0]
    v_mad_u32_u16 v174, v30, s36, v194 op_sel:[1,0,0,0]
    v_mad_u32_u16 v175, v31, s36, v195 op_sel:[1,0,0,0]
    buffer_load_dwordx4 v172, s[8:11], 0 offen lds
    s_add_u32 m0, m0, 1024
    s_nop 0
    buffer_load_dwordx4 v173, s[8:11], 0 offen lds
    s_add_u32 m0, m0, 1024
    s_nop 0
    buffer_load_dwordx4 v174, s[8:11], 0 offen lds
    s_add_u32 m0, m0, 1024
    s_nop 0
    buffer_load_dwordx4 v175, s[8:11], 0 offen lds
    s_waitcnt lgkmcnt(0)
    s_cmp_lt_u32 s86, 2
    s_cbranch_scc1 K_pre
    s_add_u32 m0, s5, 8192
    v_mad_u32_u16 v172, v32, s36, v192 op_sel:[1,0,0,0]
    v_mad_u32_u16 v173, v33, s36, v193 op_sel:[1,0,0,0]
    v_mad_u32_u16 v174, v34, s36, v194 op_sel:[1,0,0,0]
    v_mad_u32_u16 v175, v35, s36, v195 op_sel:[1,0,0,0]
    buffer_load_dwordx4 v172, s[8:11], 0 offen lds
    s_add_u32 m0, m0, 1024
    s_nop 0
    buffer_load_dwordx4 v173, s[8:11], 0 offen lds
    s_add_u32 m0, m0, 1024
    s_nop 0
    buffer_load_dwordx4 v174, s[8:11], 0 offen lds
    s_add_u32 m0, m0, 1024
    s_nop 0
    buffer_load_dwordx4 v175, s[8:11], 0 offen lds
K_pre:
    v_bfe_u32 v3, v0, 4, 2
    v_bfe_u32 v6, v0, 2, 2
    v_and_b32 v7, 3, v0
    v_lshlrev_b32 v5, 8, v6
    v_mul_u32_u24 v3, 1032, v3
    v_lshl_add_u32 v5, v7, 6, v5
    v_add_u32 v3, 104448, v3
    v_lshl_add_u32 v5, v6, 4, v5
    v_add_u32 v208, v3, v5
    v_xor_b32 v209, 16, v5
    v_add_u32 v209, v3, v209
    v_xor_b32 v210, 32, v5
    v_add_u32 v210, v3, v210
    v_xor_b32 v211, 48, v5
    v_add_u32 v211, v3, v211
    ds_read_b64_tr_b16 v[212:213], v208 offset:0
    ds_read_b64_tr_b16 v[214:215], v208 offset:4128
    ds_read_b64_tr_b16 v[216:217], v208 offset:8256
    ds_read_b64_tr_b16 v[218:219], v208 offset:12384
    ds_read_b64_tr_b16 v[220:221], v208 offset:16512
    ds_read_b64_tr_b16 v[222:223], v208 offset:20640
    ds_read_b64_tr_b16 v[224:225], v208 offset:24768
    ds_read_b64_tr_b16 v[226:227], v208 offset:28896
    ds_read_b64_tr_b16 v[228:229], v208 offset:8
    ds_read_b64_tr_b16 v[230:231], v208 offset:4136
    ds_read_b64_tr_b16 v[232:233], v208 offset:8264
    ds_read_b64_tr_b16 v[234:235], v208 offset:12392
    ds_read_b64_tr_b16 v[236:237], v208 offset:16520
    ds_read_b64_tr_b16 v[238:239], v208 offset:20648
    ds_read_b64_tr_b16 v[240:241], v208 offset:24776
    ds_read_b64_tr_b16 v[242:243], v208 offset:28904
    s_cmp_eq_u32 s86, 0
    s_cbranch_scc1 K_done
K_it0:
    s_cmp_lt_u32 s86, 2
    s_cbranch_scc1 K_w0_0
    s_waitcnt vmcnt(8)
    s_branch K_w1_0
K_w0_0:
    s_waitcnt vmcnt(4)
K_w1_0:
    ds_read_b128 v[96:99], v180 offset:0
    ds_read_b128 v[100:103], v181 offset:0
    ds_read_b128 v[104:107], v182 offset:0
    ds_read_b128 v[108:111], v183 offset:0
    ds_read_b128 v[36:39], v200 offset:192
    ds_read_b64_tr_b16 v[128:129], v184 offset:0
    ds_read_b64_tr_b16 v[132:133], v185 offset:0
    ds_read_b64_tr_b16 v[136:137], v186 offset:0
    ds_read_b64_tr_b16 v[140:141], v187 offset:0
    ds_read_b64_tr_b16 v[144:145], v188 offset:0
    ds_read_b64_tr_b16 v[148:149], v189 offset:0
    ds_read_b64_tr_b16 v[152:153], v190 offset:0
    ds_read_b64_tr_b16 v[156:157], v191 offset:0
    ds_read_b128 v[40:43], v200 offset:256
    v_cmp_eq_u32_sdwa s[40:41], v24, v196 src0_sel:WORD_0 src1_sel:DWORD
    v_cmp_eq_u32_sdwa s[42:43], v25, v196 src0_sel:WORD_0 src1_sel:DWORD
    v_cmp_eq_u32_sdwa s[44:45], v26, v196 src0_sel:WORD_0 src1_sel:DWORD
    v_cmp_eq_u32_sdwa s[46:47], v27, v196 src0_sel:WORD_0 src1_sel:DWORD
    v_cmp_eq_u32_sdwa s[48:49], v28, v196 src0_sel:WORD_0 src1_sel:DWORD
    v_cmp_eq_u32_sdwa s[50:51], v29, v196 src0_sel:WORD_0 src1_sel:DWORD
    v_cmp_eq_u32_sdwa s[52:53], v30, v196 src0_sel:WORD_0 src1_sel:DWORD
    v_cmp_eq_u32_sdwa s[54:55], v31, v196 src0_sel:WORD_0 src1_sel:DWORD
    s_waitcnt lgkmcnt(10)
    v_mfma_f32_16x16x32_bf16 v[160:163], v[96:99], v[48:51], 0
    v_mfma_f32_16x16x32_bf16 v[160:163], v[100:103], v[52:55], v[160:163]
    v_mfma_f32_16x16x32_bf16 v[160:163], v[104:107], v[56:59], v[160:163]
    v_mfma_f32_16x16x32_bf16 v[160:163], v[108:111], v[60:63], v[160:163]
    s_waitcnt lgkmcnt(1)
    s_cbranch_scc1 K_w2_0
    s_add_u32 m0, s5, 0
    v_mad_u32_u16 v172, v36, s36, v192 op_sel:[1,0,0,0]
    v_mad_u32_u16 v173, v37, s36, v193 op_sel:[1,0,0,0]
    v_mad_u32_u16 v174, v38, s36, v194 op_sel:[1,0,0,0]
    v_mad_u32_u16 v175, v39, s36, v195 op_sel:[1,0,0,0]
    buffer_load_dwordx4 v172, s[8:11], 0 offen lds
    s_add_u32 m0, m0, 1024
    s_nop 0
    buffer_load_dwordx4 v173, s[8:11], 0 offen lds
    s_add_u32 m0, m0, 1024
    s_nop 0
    buffer_load_dwordx4 v174, s[8:11], 0 offen lds
    s_add_u32 m0, m0, 1024
    s_nop 0
    buffer_load_dwordx4 v175, s[8:11], 0 offen lds
    s_waitcnt vmcnt(8)
    s_branch K_w3_0
K_w2_0:
    s_waitcnt vmcnt(0)
K_w3_0:
    ds_read_b128 v[112:115], v180 offset:4096
    ds_read_b128 v[116:119], v181 offset:4096
    ds_read_b128 v[120:123], v182 offset:4096
    ds_read_b128 v[124:127], v183 offset:4096
    ds_read_b64_tr_b16 v[130:131], v184 offset:4096
    ds_read_b64_tr_b16 v[134:135], v185 offset:4096
    ds_read_b64_tr_b16 v[138:139], v186 offset:4096
    ds_read_b64_tr_b16 v[142:143], v187 offset:4096
    ds_read_b64_tr_b16 v[146:147], v188 offset:4096
    ds_read_b64_tr_b16 v[150:151], v189 offset:4096
    ds_read_b64_tr_b16 v[154:155], v190 offset:4096
    ds_read_b64_tr_b16 v[158:159], v191 offset:4096
    v_exp_f32 v160, v160
    v_exp_f32 v161, v161
    v_exp_f32 v162, v162
    v_exp_f32 v163, v163
    v_add_f32 v160, 1.0, v160
    v_add_f32 v161, 1.0, v161
    v_add_f32 v162, 1.0, v162
    v_add_f32 v163, 1.0, v163
    v_rcp_f32 v160, v160
    v_rcp_f32 v161, v161
    v_rcp_f32 v162, v162
    v_rcp_f32 v163, v163
    v_cndmask_b32 v160, 0, v160, s[40:41]
    v_cndmask_b32 v161, 0, v161, s[42:43]
    v_cndmask_b32 v162, 0, v162, s[44:45]
    v_cndmask_b32 v163, 0, v163, s[46:47]
    v_cvt_pk_bf16_f32 v168, v160, v161
    v_cvt_pk_bf16_f32 v169, v162, v163
    s_waitcnt lgkmcnt(8)
    v_mfma_f32_16x16x32_bf16 v[164:167], v[112:115], v[48:51], 0
    v_mfma_f32_16x16x32_bf16 v[164:167], v[116:119], v[52:55], v[164:167]
    v_mfma_f32_16x16x32_bf16 v[164:167], v[120:123], v[56:59], v[164:167]
    v_mfma_f32_16x16x32_bf16 v[164:167], v[124:127], v[60:63], v[164:167]
    s_cmp_lt_u32 s86, 3
    s_waitcnt lgkmcnt(0)
    s_cbranch_scc1 K_nd_0
    s_add_u32 m0, s5, 4096
    v_mad_u32_u16 v172, v40, s36, v192 op_sel:[1,0,0,0]
    v_mad_u32_u16 v173, v41, s36, v193 op_sel:[1,0,0,0]
    v_mad_u32_u16 v174, v42, s36, v194 op_sel:[1,0,0,0]
    v_mad_u32_u16 v175, v43, s36, v195 op_sel:[1,0,0,0]
    buffer_load_dwordx4 v172, s[8:11], 0 offen lds
    s_add_u32 m0, m0, 1024
    s_nop 0
    buffer_load_dwordx4 v173, s[8:11], 0 offen lds
    s_add_u32 m0, m0, 1024
    s_nop 0
    buffer_load_dwordx4 v174, s[8:11], 0 offen lds
    s_add_u32 m0, m0, 1024
    s_nop 0
    buffer_load_dwordx4 v175, s[8:11], 0 offen lds
    s_branch K_ne_0
K_nd_0:
    s_nop 5
K_ne_0:
    v_exp_f32 v164, v164
    v_exp_f32 v165, v165
    v_exp_f32 v166, v166
    v_exp_f32 v167, v167
    v_add_f32 v164, 1.0, v164
    v_add_f32 v165, 1.0, v165
    v_add_f32 v166, 1.0, v166
    v_add_f32 v167, 1.0, v167
    v_rcp_f32 v164, v164
    v_rcp_f32 v165, v165
    v_rcp_f32 v166, v166
    v_rcp_f32 v167, v167
    v_cndmask_b32 v164, 0, v164, s[48:49]
    v_cndmask_b32 v165, 0, v165, s[50:51]
    v_cndmask_b32 v166, 0, v166, s[52:53]
    v_cndmask_b32 v167, 0, v167, s[54:55]
    v_cvt_pk_bf16_f32 v170, v164, v165
    v_cvt_pk_bf16_f32 v171, v166, v167
    s_nop 1
    v_mfma_f32_16x16x32_bf16 v[64:67], v[128:131], v[168:171], v[64:67]
    v_mfma_f32_16x16x32_bf16 v[68:71], v[132:135], v[168:171], v[68:71]
    v_mfma_f32_16x16x32_bf16 v[72:75], v[136:139], v[168:171], v[72:75]
    v_mfma_f32_16x16x32_bf16 v[76:79], v[140:143], v[168:171], v[76:79]
    v_mfma_f32_16x16x32_bf16 v[80:83], v[144:147], v[168:171], v[80:83]
    v_mfma_f32_16x16x32_bf16 v[84:87], v[148:151], v[168:171], v[84:87]
    v_mfma_f32_16x16x32_bf16 v[88:91], v[152:155], v[168:171], v[88:91]
    v_mfma_f32_16x16x32_bf16 v[92:95], v[156:159], v[168:171], v[92:95]
    s_sub_u32 s86, s86, 1
    s_cmp_eq_u32 s86, 0
    s_cbranch_scc1 K_done
    s_cmp_gt_u32 s86, 5
    s_cbranch_scc1 K_pr_0
    s_setprio 2
    s_cmp_gt_u32 s86, 3
    s_cbranch_scc1 K_pr_0
    s_setprio 1
    s_cmp_gt_u32 s86, 1
    s_cbranch_scc1 K_pr_0
    s_setprio 0
K_pr_0:
K_it1:
    s_cmp_lt_u32 s86, 2
    s_cbranch_scc1 K_w0_1
    s_waitcnt vmcnt(8)
    s_branch K_w1_1
K_w0_1:
    s_waitcnt vmcnt(4)
K_w1_1:
    ds_read_b128 v[96:99], v180 offset:8192
    ds_read_b128 v[100:103], v181 offset:8192
    ds_read_b128 v[104:107], v182 offset:8192
    ds_read_b128 v[108:111], v183 offset:8192
    ds_read_b128 v[44:47], v200 offset:320
    ds_read_b64_tr_b16 v[128:129], v184 offset:8192
    ds_read_b64_tr_b16 v[132:133], v185 offset:8192
    ds_read_b64_tr_b16 v[136:137], v186 offset:8192
    ds_read_b64_tr_b16 v[140:141], v187 offset:8192
    ds_read_b64_tr_b16 v[144:145], v188 offset:8192
    ds_read_b64_tr_b16 v[148:149], v189 offset:8192
    ds_read_b64_tr_b16 v[152:153], v190 offset:8192
    ds_read_b64_tr_b16 v[156:157], v191 offset:8192
    ds_read_b128 v[24:27], v200 offset:384
    v_cmp_eq_u32_sdwa s[40:41], v32, v196 src0_sel:WORD_0 src1_sel:DWORD
    v_cmp_eq_u32_sdwa s[42:43], v33, v196 src0_sel:WORD_0 src1_sel:DWORD
    v_cmp_eq_u32_sdwa s[44:45], v34, v196 src0_sel:WORD_0 src1_sel:DWORD
    v_cmp_eq_u32_sdwa s[46:47], v35, v196 src0_sel:WORD_0 src1_sel:DWORD
    v_cmp_eq_u32_sdwa s[48:49], v36, v196 src0_sel:WORD_0 src1_sel:DWORD
    v_cmp_eq_u32_sdwa s[50:51], v37, v196 src0_sel:WORD_0 src1_sel:DWORD
    v_cmp_eq_u32_sdwa s[52:53], v38, v196 src0_sel:WORD_0 src1_sel:DWORD
    v_cmp_eq_u32_sdwa s[54:55], v39, v196 src0_sel:WORD_0 src1_sel:DWORD
    s_waitcnt lgkmcnt(10)
    v_mfma_f32_16x16x32_bf16 v[160:163], v[96:99], v[48:51], 0
    v_mfma_f32_16x16x32_bf16 v[160:163], v[100:103], v[52:55], v[160:163]
    v_mfma_f32_16x16x32_bf16 v[160:163], v[104:107], v[56:59], v[160:163]
    v_mfma_f32_16x16x32_bf16 v[160:163], v[108:111], v[60:63], v[160:163]
    s_waitcnt lgkmcnt(1)
    s_cbranch_scc1 K_w2_1
    s_add_u32 m0, s5, 8192
    v_mad_u32_u16 v172, v44, s36, v192 op_sel:[1,0,0,0]
    v_mad_u32_u16 v173, v45, s36, v193 op_sel:[1,0,0,0]
    v_mad_u32_u16 v174, v46, s36, v194 op_sel:[1,0,0,0]
    v_mad_u32_u16 v175, v47, s36, v195 op_sel:[1,0,0,0]
    buffer_load_dwordx4 v172, s[8:11], 0 offen lds
    s_add_u32 m0, m0, 1024
    s_nop 0
    buffer_load_dwordx4 v173, s[8:11], 0 offen lds
    s_add_u32 m0, m0, 1024
    s_nop 0
    buffer_load_dwordx4 v174, s[8:11], 0 offen lds
    s_add_u32 m0, m0, 1024
    s_nop 0
    buffer_load_dwordx4 v175, s[8:11], 0 offen lds
    s_waitcnt vmcnt(8)
    s_branch K_w3_1
K_w2_1:
    s_waitcnt vmcnt(0)
K_w3_1:
    ds_read_b128 v[112:115], v180 offset:0
    ds_read_b128 v[116:119], v181 offset:0
    ds_read_b128 v[120:123], v182 offset:0
    ds_read_b128 v[124:127], v183 offset:0
    ds_read_b64_tr_b16 v[130:131], v184 offset:0
    ds_read_b64_tr_b16 v[134:135], v185 offset:0
    ds_read_b64_tr_b16 v[138:139], v186 offset:0
    ds_read_b64_tr_b16 v[142:143], v187 offset:0
    ds_read_b64_tr_b16 v[146:147], v188 offset:0
    ds_read_b64_tr_b16 v[150:151], v189 offset:0
    ds_read_b64_tr_b16 v[154:155], v190 offset:0
    ds_read_b64_tr_b16 v[158:159], v191 offset:0
    v_exp_f32 v160, v160
    v_exp_f32 v161, v161
    v_exp_f32 v162, v162
    v_exp_f32 v163, v163
    v_add_f32 v160, 1.0, v160
    v_add_f32 v161, 1.0, v161
    v_add_f32 v162, 1.0, v162
    v_add_f32 v163, 1.0, v163
    v_rcp_f32 v160, v160
    v_rcp_f32 v161, v161
    v_rcp_f32 v162, v162
    v_rcp_f32 v163, v163
    v_cndmask_b32 v160, 0, v160, s[40:41]
    v_cndmask_b32 v161, 0, v161, s[42:43]
    v_cndmask_b32 v162, 0, v162, s[44:45]
    v_cndmask_b32 v163, 0, v163, s[46:47]
    v_cvt_pk_bf16_f32 v168, v160, v161
    v_cvt_pk_bf16_f32 v169, v162, v163
    s_waitcnt lgkmcnt(8)
    v_mfma_f32_16x16x32_bf16 v[164:167], v[112:115], v[48:51], 0
    v_mfma_f32_16x16x32_bf16 v[164:167], v[116:119], v[52:55], v[164:167]
    v_mfma_f32_16x16x32_bf16 v[164:167], v[120:123], v[56:59], v[164:167]
    v_mfma_f32_16x16x32_bf16 v[164:167], v[124:127], v[60:63], v[164:167]
    s_cmp_lt_u32 s86, 3
    s_waitcnt lgkmcnt(0)
    s_cbranch_scc1 K_nd_1
    s_add_u32 m0, s5, 0
    v_mad_u32_u16 v172, v24, s36, v192 op_sel:[1,0,0,0]
    v_mad_u32_u16 v173, v25, s36, v193 op_sel:[1,0,0,0]
    v_mad_u32_u16 v174, v26, s36, v194 op_sel:[1,0,0,0]
    v_mad_u32_u16 v175, v27, s36, v195 op_sel:[1,0,0,0]
    buffer_load_dwordx4 v172, s[8:11], 0 offen lds
    s_add_u32 m0, m0, 1024
    s_nop 0
    buffer_load_dwordx4 v173, s[8:11], 0 offen lds
    s_add_u32 m0, m0, 1024
    s_nop 0
    buffer_load_dwordx4 v174, s[8:11], 0 offen lds
    s_add_u32 m0, m0, 1024
    s_nop 0
    buffer_load_dwordx4 v175, s[8:11], 0 offen lds
    s_branch K_ne_1
K_nd_1:
    s_nop 5
K_ne_1:
    v_exp_f32 v164, v164
    v_exp_f32 v165, v165
    v_exp_f32 v166, v166
    v_exp_f32 v167, v167
    v_add_f32 v164, 1.0, v164
    v_add_f32 v165, 1.0, v165
    v_add_f32 v166, 1.0, v166
    v_add_f32 v167, 1.0, v167
    v_rcp_f32 v164, v164
    v_rcp_f32 v165, v165
    v_rcp_f32 v166, v166
    v_rcp_f32 v167, v167
    v_cndmask_b32 v164, 0, v164, s[48:49]
    v_cndmask_b32 v165, 0, v165, s[50:51]
    v_cndmask_b32 v166, 0, v166, s[52:53]
    v_cndmask_b32 v167, 0, v167, s[54:55]
    v_cvt_pk_bf16_f32 v170, v164, v165
    v_cvt_pk_bf16_f32 v171, v166, v167
    s_nop 1
    v_mfma_f32_16x16x32_bf16 v[64:67], v[128:131], v[168:171], v[64:67]
    v_mfma_f32_16x16x32_bf16 v[68:71], v[132:135], v[168:171], v[68:71]
    v_mfma_f32_16x16x32_bf16 v[72:75], v[136:139], v[168:171], v[72:75]
    v_mfma_f32_16x16x32_bf16 v[76:79], v[140:143], v[168:171], v[76:79]
    v_mfma_f32_16x16x32_bf16 v[80:83], v[144:147], v[168:171], v[80:83]
    v_mfma_f32_16x16x32_bf16 v[84:87], v[148:151], v[168:171], v[84:87]
    v_mfma_f32_16x16x32_bf16 v[88:91], v[152:155], v[168:171], v[88:91]
    v_mfma_f32_16x16x32_bf16 v[92:95], v[156:159], v[168:171], v[92:95]
    s_sub_u32 s86, s86, 1
    s_cmp_eq_u32 s86, 0
    s_cbranch_scc1 K_done
    s_cmp_gt_u32 s86, 5
    s_cbranch_scc1 K_pr_1
    s_setprio 2
    s_cmp_gt_u32 s86, 3
    s_cbranch_scc1 K_pr_1
    s_setprio 1
    s_cmp_gt_u32 s86, 1
    s_cbranch_scc1 K_pr_1
    s_setprio 0
K_pr_1:
K_it2:
    s_cmp_lt_u32 s86, 2
    s_cbranch_scc1 K_w0_2
    s_waitcnt vmcnt(8)
    s_branch K_w1_2
K_w0_2:
    s_waitcnt vmcnt(4)
K_w1_2:
    ds_read_b128 v[96:99], v180 offset:4096
    ds_read_b128 v[100:103], v181 offset:4096
    ds_read_b128 v[104:107], v182 offset:4096
    ds_read_b128 v[108:111], v183 offset:4096
    ds_read_b128 v[28:31], v200 offset:448
    ds_read_b64_tr_b16 v[128:129], v184 offset:4096
    ds_read_b64_tr_b16 v[132:133], v185 offset:4096
    ds_read_b64_tr_b16 v[136:137], v186 offset:4096
    ds_read_b64_tr_b16 v[140:141], v187 offset:4096
    ds_read_b64_tr_b16 v[144:145], v188 offset:4096
    ds_read_b64_tr_b16 v[148:149], v189 offset:4096
    ds_read_b64_tr_b16 v[152:153], v190 offset:4096
    ds_read_b64_tr_b16 v[156:157], v191 offset:4096
    ds_read_b128 v[32:35], v200 offset:512
    v_cmp_eq_u32_sdwa s[40:41], v40, v196 src0_sel:WORD_0 src1_sel:DWORD
    v_cmp_eq_u32_sdwa s[42:43], v41, v196 src0_sel:WORD_0 src1_sel:DWORD
    v_cmp_eq_u32_sdwa s[44:45], v42, v196 src0_sel:WORD_0 src1_sel:DWORD
    v_cmp_eq_u32_sdwa s[46:47], v43, v196 src0_sel:WORD_0 src1_sel:DWORD
    v_cmp_eq_u32_sdwa s[48:49], v44, v196 src0_sel:WORD_0 src1_sel:DWORD
    v_cmp_eq_u32_sdwa s[50:51], v45, v196 src0_sel:WORD_0 src1_sel:DWORD
    v_cmp_eq_u32_sdwa s[52:53], v46, v196 src0_sel:WORD_0 src1_sel:DWORD
    v_cmp_eq_u32_sdwa s[54:55], v47, v196 src0_sel:WORD_0 src1_sel:DWORD
    s_waitcnt lgkmcnt(10)
    v_mfma_f32_16x16x32_bf16 v[160:163], v[96:99], v[48:51], 0
    v_mfma_f32_16x16x32_bf16 v[160:163], v[100:103], v[52:55], v[160:163]
    v_mfma_f32_16x16x32_bf16 v[160:163], v[104:107], v[56:59], v[160:163]
    v_mfma_f32_16x16x32_bf16 v[160:163], v[108:111], v[60:63], v[160:163]
    s_waitcnt lgkmcnt(1)
    s_cbranch_scc1 K_w2_2
    s_add_u32 m0, s5, 4096
    v_mad_u32_u16 v172, v28, s36, v192 op_sel:[1,0,0,0]
    v_mad_u32_u16 v173, v29, s36, v193 op_sel:[1,0,0,0]
    v_mad_u32_u16 v174, v30, s36, v194 op_sel:[1,0,0,0]
    v_mad_u32_u16 v175, v31, s36, v195 op_sel:[1,0,0,0]
    buffer_load_dwordx4 v172, s[8:11], 0 offen lds
    s_add_u32 m0, m0, 1024
    s_nop 0
    buffer_load_dwordx4 v173, s[8:11], 0 offen lds
    s_add_u32 m0, m0, 1024
    s_nop 0
    buffer_load_dwordx4 v174, s[8:11], 0 offen lds
    s_add_u32 m0, m0, 1024
    s_nop 0
    buffer_load_dwordx4 v175, s[8:11], 0 offen lds
    s_waitcnt vmcnt(8)
    s_branch K_w3_2
K_w2_2:
    s_waitcnt vmcnt(0)
K_w3_2:
    ds_read_b128 v[112:115], v180 offset:8192
    ds_read_b128 v[116:119], v181 offset:8192
    ds_read_b128 v[120:123], v182 offset:8192
    ds_read_b128 v[124:127], v183 offset:8192
    ds_read_b64_tr_b16 v[130:131], v184 offset:8192
    ds_read_b64_tr_b16 v[134:135], v185 offset:8192
    ds_read_b64_tr_b16 v[138:139], v186 offset:8192
    ds_read_b64_tr_b16 v[142:143], v187 offset:8192
    ds_read_b64_tr_b16 v[146:147], v188 offset:8192
    ds_read_b64_tr_b16 v[150:151], v189 offset:8192
    ds_read_b64_tr_b16 v[154:155], v190 offset:8192
    ds_read_b64_tr_b16 v[158:159], v191 offset:8192
    v_exp_f32 v160, v160
    v_exp_f32 v161, v161
    v_exp_f32 v162, v162
    v_exp_f32 v163, v163
    v_add_f32 v160, 1.0, v160
    v_add_f32 v161, 1.0, v161
    v_add_f32 v162, 1.0, v162
    v_add_f32 v163, 1.0, v163
    v_rcp_f32 v160, v160
    v_rcp_f32 v161, v161
    v_rcp_f32 v162, v162
    v_rcp_f32 v163, v163
    v_cndmask_b32 v160, 0, v160, s[40:41]
    v_cndmask_b32 v161, 0, v161, s[42:43]
    v_cndmask_b32 v162, 0, v162, s[44:45]
    v_cndmask_b32 v163, 0, v163, s[46:47]
    v_cvt_pk_bf16_f32 v168, v160, v161
    v_cvt_pk_bf16_f32 v169, v162, v163
    s_waitcnt lgkmcnt(8)
    v_mfma_f32_16x16x32_bf16 v[164:167], v[112:115], v[48:51], 0
    v_mfma_f32_16x16x32_bf16 v[164:167], v[116:119], v[52:55], v[164:167]
    v_mfma_f32_16x16x32_bf16 v[164:167], v[120:123], v[56:59], v[164:167]
    v_mfma_f32_16x16x32_bf16 v[164:167], v[124:127], v[60:63], v[164:167]
    s_cmp_lt_u32 s86, 3
    s_waitcnt lgkmcnt(0)
    s_cbranch_scc1 K_nd_2
    s_add_u32 m0, s5, 8192
    v_mad_u32_u16 v172, v32, s36, v192 op_sel:[1,0,0,0]
    v_mad_u32_u16 v173, v33, s36, v193 op_sel:[1,0,0,0]
    v_mad_u32_u16 v174, v34, s36, v194 op_sel:[1,0,0,0]
    v_mad_u32_u16 v175, v35, s36, v195 op_sel:[1,0,0,0]
    buffer_load_dwordx4 v172, s[8:11], 0 offen lds
    s_add_u32 m0, m0, 1024
    s_nop 0
    buffer_load_dwordx4 v173, s[8:11], 0 offen lds
    s_add_u32 m0, m0, 1024
    s_nop 0
    buffer_load_dwordx4 v174, s[8:11], 0 offen lds
    s_add_u32 m0, m0, 1024
    s_nop 0
    buffer_load_dwordx4 v175, s[8:11], 0 offen lds
    s_branch K_ne_2
K_nd_2:
    s_nop 5
K_ne_2:
    v_exp_f32 v164, v164
    v_exp_f32 v165, v165
    v_exp_f32 v166, v166
    v_exp_f32 v167, v167
    v_add_f32 v164, 1.0, v164
    v_add_f32 v165, 1.0, v165
    v_add_f32 v166, 1.0, v166
    v_add_f32 v167, 1.0, v167
    v_rcp_f32 v164, v164
    v_rcp_f32 v165, v165
    v_rcp_f32 v166, v166
    v_rcp_f32 v167, v167
    v_cndmask_b32 v164, 0, v164, s[48:49]
    v_cndmask_b32 v165, 0, v165, s[50:51]
    v_cndmask_b32 v166, 0, v166, s[52:53]
    v_cndmask_b32 v167, 0, v167, s[54:55]
    v_cvt_pk_bf16_f32 v170, v164, v165
    v_cvt_pk_bf16_f32 v171, v166, v167
    s_nop 1
    v_mfma_f32_16x16x32_bf16 v[64:67], v[128:131], v[168:171], v[64:67]
    v_mfma_f32_16x16x32_bf16 v[68:71], v[132:135], v[168:171], v[68:71]
    v_mfma_f32_16x16x32_bf16 v[72:75], v[136:139], v[168:171], v[72:75]
    v_mfma_f32_16x16x32_bf16 v[76:79], v[140:143], v[168:171], v[76:79]
    v_mfma_f32_16x16x32_bf16 v[80:83], v[144:147], v[168:171], v[80:83]
    v_mfma_f32_16x16x32_bf16 v[84:87], v[148:151], v[168:171], v[84:87]
    v_mfma_f32_16x16x32_bf16 v[88:91], v[152:155], v[168:171], v[88:91]
    v_mfma_f32_16x16x32_bf16 v[92:95], v[156:159], v[168:171], v[92:95]
    s_sub_u32 s86, s86, 1
    s_cmp_eq_u32 s86, 0
    s_cbranch_scc1 K_done
    s_cmp_gt_u32 s86, 5
    s_cbranch_scc1 K_pr_2
    s_setprio 2
    s_cmp_gt_u32 s86, 3
    s_cbranch_scc1 K_pr_2
    s_setprio 1
    s_cmp_gt_u32 s86, 1
    s_cbranch_scc1 K_pr_2
    s_setprio 0
K_pr_2:
    v_add_u32 v200, 384, v200
    s_branch K_it0
K_done:
    s_waitcnt lgkmcnt(0)
    s_setprio 0
    s_add_u32 s80, s80, 2048
    s_cmp_lt_u32 s80, s83
    s_cbranch_scc0 K_nosub
    s_barrier
    s_branch K_sub
K_nosub:
    s_cmp_lt_u32 s77, s85
    s_cbranch_scc0 K_epi
    s_barrier
    v_lshlrev_b32 v7, 11, v0
    v_add_u32 v7, 137472, v7
    v_lshlrev_b32 v6, 2, v0
    v_cmp_gt_u32 vcc, 8, v0
    s_and_saveexec_b64 s[56:57], vcc
    ds_write_b32 v6, v7 offset:1024
    s_mov_b64 exec, -1
    v_mov_b32 v5, s77
    ds_read_b32 v5, v5 offset:1152
    s_add_u32 s77, s77, 4
    s_waitcnt lgkmcnt(0)
    s_nop 0
    v_readfirstlane_b32 s84, v5
    s_mul_i32 s84, s84, 3136
    v_lshl_add_u32 v1, v0, 2, s84
    v_lshlrev_b32 v2, 2, v1
    s_movk_i32 s87, 0x2000
    buffer_load_dwordx4 v[96:99], v2, s[32:35], 0 offen
    buffer_load_dwordx4 v[100:103], v2, s[32:35], s87 offen
    buffer_load_dwordx4 v[104:107], v2, s[28:31], 0 offen
    buffer_load_dwordx4 v[108:111], v2, s[28:31], s87 offen
    s_mov_b32 s88, 400000
    v_cmp_gt_u32 s[90:91], s88, v1
    v_add_u32 v1, 2048, v1
    v_cmp_gt_u32 s[56:57], s88, v1
    v_cmp_gt_u32 vcc, 272, v0
    s_and_b64 s[56:57], s[56:57], vcc
    s_movk_i32 s88, -392
    s_waitcnt vmcnt(0)
    v_mul_u32_u24 v5, 21400, v96
    v_lshrrev_b32 v5, 21, v5
    v_lshlrev_b32 v6, 2, v96
    v_mad_i32_i24 v6, v5, s88, v6
    v_lshl_or_b32 v6, v104, 16, v6
    v_cmp_eq_u32 vcc, s2, v5
    s_and_b64 vcc, vcc, s[90:91]
    s_nop 1
    v_cndmask_b32 v8, v202, v6, vcc
    v_mul_u32_u24 v5, 21400, v97
    v_lshrrev_b32 v5, 21, v5
    v_lshlrev_b32 v6, 2, v97
    v_mad_i32_i24 v6, v5, s88, v6
    v_lshl_or_b32 v6, v105, 16, v6
    v_cmp_eq_u32 vcc, s2, v5
    s_and_b64 vcc, vcc, s[90:91]
    s_nop 1
    v_cndmask_b32 v9, v202, v6, vcc
    v_mul_u32_u24 v5, 21400, v98
    v_lshrrev_b32 v5, 21, v5
    v_lshlrev_b32 v6, 2, v98
    v_mad_i32_i24 v6, v5, s88, v6
    v_lshl_or_b32 v6, v106, 16, v6
    v_cmp_eq_u32 vcc, s2, v5
    s_and_b64 vcc, vcc, s[90:91]
    s_nop 1
    v_cndmask_b32 v10, v202, v6, vcc
    v_mul_u32_u24 v5, 21400, v99
    v_lshrrev_b32 v5, 21, v5
    v_lshlrev_b32 v6, 2, v99
    v_mad_i32_i24 v6, v5, s88, v6
    v_lshl_or_b32 v6, v107, 16, v6
    v_cmp_eq_u32 vcc, s2, v5
    s_and_b64 vcc, vcc, s[90:91]
    s_nop 1
    v_cndmask_b32 v11, v202, v6, vcc
    v_mul_u32_u24 v5, 21400, v100
    v_lshrrev_b32 v5, 21, v5
    v_lshlrev_b32 v6, 2, v100
    v_mad_i32_i24 v6, v5, s88, v6
    v_lshl_or_b32 v6, v108, 16, v6
    v_cmp_eq_u32 vcc, s2, v5
    s_and_b64 vcc, vcc, s[56:57]
    s_nop 1
    v_cndmask_b32 v12, v202, v6, vcc
    v_mul_u32_u24 v5, 21400, v101
    v_lshrrev_b32 v5, 21, v5
    v_lshlrev_b32 v6, 2, v101
    v_mad_i32_i24 v6, v5, s88, v6
    v_lshl_or_b32 v6, v109, 16, v6
    v_cmp_eq_u32 vcc, s2, v5
    s_and_b64 vcc, vcc, s[56:57]
    s_nop 1
    v_cndmask_b32 v13, v202, v6, vcc
    v_mul_u32_u24 v5, 21400, v102
    v_lshrrev_b32 v5, 21, v5
    v_lshlrev_b32 v6, 2, v102
    v_mad_i32_i24 v6, v5, s88, v6
    v_lshl_or_b32 v6, v110, 16, v6
    v_cmp_eq_u32 vcc, s2, v5
    s_and_b64 vcc, vcc, s[56:57]
    s_nop 1
    v_cndmask_b32 v14, v202, v6, vcc
    v_mul_u32_u24 v5, 21400, v103
    v_lshrrev_b32 v5, 21, v5
    v_lshlrev_b32 v6, 2, v103
    v_mad_i32_i24 v6, v5, s88, v6
    v_lshl_or_b32 v6, v111, 16, v6
    v_cmp_eq_u32 vcc, s2, v5
    s_and_b64 vcc, vcc, s[56:57]
    s_nop 1
    v_cndmask_b32 v15, v202, v6, vcc
    s_branch K_round
K_geninit:
    s_waitcnt lgkmcnt(0)
    s_barrier
    v_lshlrev_b32 v7, 11, v0
    v_add_u32 v7, 137472, v7
    v_lshlrev_b32 v6, 2, v0
    v_cmp_gt_u32 vcc, 8, v0
    s_and_saveexec_b64 s[56:57], vcc
    ds_write_b32 v6, v7 offset:1024
    s_mov_b64 exec, -1
K_round:
    s_waitcnt lgkmcnt(0)
    s_barrier
    v_and_b32 v5, 28, v8
    v_mov_b32 v16, -1
    v_cmpx_gt_u32 vcc, s78, v8
    ds_add_rtn_u32 v16, v5, v199 offset:1024
    s_mov_b64 exec, -1
    v_and_b32 v5, 28, v9
    v_mov_b32 v17, -1
    v_cmpx_gt_u32 vcc, s78, v9
    ds_add_rtn_u32 v17, v5, v199 offset:1024
    s_mov_b64 exec, -1
    v_and_b32 v5, 28, v10
    v_mov_b32 v18, -1
    v_cmpx_gt_u32 vcc, s78, v10
    ds_add_rtn_u32 v18, v5, v199 offset:1024
    s_mov_b64 exec, -1
    v_and_b32 v5, 28, v11
    v_mov_b32 v19, -1
    v_cmpx_gt_u32 vcc, s78, v11
    ds_add_rtn_u32 v19, v5, v199 offset:1024
    s_mov_b64 exec, -1
    v_and_b32 v5, 28, v12
    v_mov_b32 v20, -1
    v_cmpx_gt_u32 vcc, s78, v12
    ds_add_rtn_u32 v20, v5, v199 offset:1024
    s_mov_b64 exec, -1
    v_and_b32 v5, 28, v13
    v_mov_b32 v21, -1
    v_cmpx_gt_u32 vcc, s78, v13
    ds_add_rtn_u32 v21, v5, v199 offset:1024
    s_mov_b64 exec, -1
    v_and_b32 v5, 28, v14
    v_mov_b32 v22, -1
    v_cmpx_gt_u32 vcc, s78, v14
    ds_add_rtn_u32 v22, v5, v199 offset:1024
    s_mov_b64 exec, -1
    v_and_b32 v5, 28, v15
    v_mov_b32 v23, -1
    v_cmpx_gt_u32 vcc, s78, v15
    ds_add_rtn_u32 v23, v5, v199 offset:1024
    s_mov_b64 exec, -1
    s_mov_b32 s80, 0
    s_waitcnt lgkmcnt(0)
K_sub:
    s_movk_i32 s84, 2048
    v_and_b32 v5, 28, v8
    v_subrev_u32 v6, s80, v16
    v_lshlrev_b32 v5, 9, v5
    v_add_u32 v5, 137472, v5
    v_sub_u32 v5, v6, v5
    v_cmpx_gt_u32 vcc, s84, v5
    ds_write_b32 v6, v8
    s_mov_b64 exec, -1
    v_and_b32 v5, 28, v9
    v_subrev_u32 v6, s80, v17
    v_lshlrev_b32 v5, 9, v5
    v_add_u32 v5, 137472, v5
    v_sub_u32 v5, v6, v5
    v_cmpx_gt_u32 vcc, s84, v5
    ds_write_b32 v6, v9
    s_mov_b64 exec, -1
    v_and_b32 v5, 28, v10
    v_subrev_u32 v6, s80, v18
    v_lshlrev_b32 v5, 9, v5
    v_add_u32 v5, 137472, v5
    v_sub_u32 v5, v6, v5
    v_cmpx_gt_u32 vcc, s84, v5
    ds_write_b32 v6, v10
    s_mov_b64 exec, -1
    v_and_b32 v5, 28, v11
    v_subrev_u32 v6, s80, v19
    v_lshlrev_b32 v5, 9, v5
    v_add_u32 v5, 137472, v5
    v_sub_u32 v5, v6, v5
    v_cmpx_gt_u32 vcc, s84, v5
    ds_write_b32 v6, v11
    s_mov_b64 exec, -1
    v_and_b32 v5, 28, v12
    v_subrev_u32 v6, s80, v20
    v_lshlrev_b32 v5, 9, v5
    v_add_u32 v5, 137472, v5
    v_sub_u32 v5, v6, v5
    v_cmpx_gt_u32 vcc, s84, v5
    ds_write_b32 v6, v12
    s_mov_b64 exec, -1
    v_and_b32 v5, 28, v13
    v_subrev_u32 v6, s80, v21
    v_lshlrev_b32 v5, 9, v5
    v_add_u32 v5, 137472, v5
    v_sub_u32 v5, v6, v5
    v_cmpx_gt_u32 vcc, s84, v5
    ds_write_b32 v6, v13
    s_mov_b64 exec, -1
    v_and_b32 v5, 28, v14
    v_subrev_u32 v6, s80, v22
    v_lshlrev_b32 v5, 9, v5
    v_add_u32 v5, 137472, v5
    v_sub_u32 v5, v6, v5
    v_cmpx_gt_u32 vcc, s84, v5
    ds_write_b32 v6, v14
    s_mov_b64 exec, -1
    v_and_b32 v5, 28, v15
    v_subrev_u32 v6, s80, v23
    v_lshlrev_b32 v5, 9, v5
    v_add_u32 v5, 137472, v5
    v_sub_u32 v5, v6, v5
    v_cmpx_gt_u32 vcc, s84, v5
    ds_write_b32 v6, v15
    s_mov_b64 exec, -1
    v_and_b32 v5, 15, v0
    v_lshlrev_b32 v6, 11, v5
    v_lshlrev_b32 v5, 2, v5
    v_add_u32 v6, 137472, v6
    s_waitcnt lgkmcnt(0)
    s_barrier
    ds_read_b32 v5, v5 offset:1024
    s_waitcnt lgkmcnt(0)
    v_sub_u32 v6, v5, v6
    v_readlane_b32 s85, v5, 8
    v_readlane_b32 s82, v6, s3
    v_readlane_b32 s83, v6, 0
    v_readlane_b32 s84, v6, 1
    s_max_u32 s83, s83, s84
    v_readlane_b32 s84, v6, 2
    s_max_u32 s83, s83, s84
    v_readlane_b32 s84, v6, 3
    s_max_u32 s83, s83, s84
    v_readlane_b32 s84, v6, 4
    s_max_u32 s83, s83, s84
    v_readlane_b32 s84, v6, 5
    s_max_u32 s83, s83, s84
    v_readlane_b32 s84, v6, 6
    s_max_u32 s83, s83, s84
    v_readlane_b32 s84, v6, 7
    s_max_u32 s83, s83, s84
    s_sub_u32 s82, s82, s80
    s_cselect_b32 s82, 0, s82
    s_min_u32 s82, s82, 2048
    s_add_u32 s84, s82, 127
    s_lshr_b32 s86, s84, 7
    v_and_b32 v5, 31, v0
    v_lshl_add_u32 v5, v5, 2, s82
    s_lshl_b32 s84, s86, 7
    v_add_u32 v6, s39, v5
    v_cmpx_gt_u32 vcc, s84, v5
    ds_write_b32 v6, v202
    s_mov_b64 exec, -1
    v_mov_b32 v200, v197
    ds_read_b128 v[24:27], v200
    ds_read_b128 v[28:31], v200 offset:64
    ds_read_b128 v[32:35], v200 offset:128
    s_branch K_listrdy
K_epi:
    ds_read_b64_tr_b16 v[96:97], v209 offset:0
    ds_read_b64_tr_b16 v[98:99], v209 offset:4128
    ds_read_b64_tr_b16 v[100:101], v209 offset:8256
    ds_read_b64_tr_b16 v[102:103], v209 offset:12384
    ds_read_b64_tr_b16 v[104:105], v209 offset:16512
    ds_read_b64_tr_b16 v[106:107], v209 offset:20640
    ds_read_b64_tr_b16 v[108:109], v209 offset:24768
    ds_read_b64_tr_b16 v[110:111], v209 offset:28896
    ds_read_b64_tr_b16 v[112:113], v209 offset:8
    ds_read_b64_tr_b16 v[114:115], v209 offset:4136
    ds_read_b64_tr_b16 v[116:117], v209 offset:8264
    ds_read_b64_tr_b16 v[118:119], v209 offset:12392
    ds_read_b64_tr_b16 v[120:121], v209 offset:16520
    ds_read_b64_tr_b16 v[122:123], v209 offset:20648
    ds_read_b64_tr_b16 v[124:125], v209 offset:24776
    ds_read_b64_tr_b16 v[126:127], v209 offset:28904
    v_cvt_pk_bf16_f32 v48, v64, v65
    v_cvt_pk_bf16_f32 v49, v66, v67
    v_cvt_pk_bf16_f32 v50, v68, v69
    v_cvt_pk_bf16_f32 v51, v70, v71
    v_cvt_pk_bf16_f32 v52, v72, v73
    v_cvt_pk_bf16_f32 v53, v74, v75
    v_cvt_pk_bf16_f32 v54, v76, v77
    v_cvt_pk_bf16_f32 v55, v78, v79
    v_cvt_pk_bf16_f32 v56, v80, v81
    v_cvt_pk_bf16_f32 v57, v82, v83
    v_cvt_pk_bf16_f32 v58, v84, v85
    v_cvt_pk_bf16_f32 v59, v86, v87
    v_cvt_pk_bf16_f32 v60, v88, v89
    v_cvt_pk_bf16_f32 v61, v90, v91
    v_cvt_pk_bf16_f32 v62, v92, v93
    v_cvt_pk_bf16_f32 v63, v94, v95
    ds_read_b64_tr_b16 v[128:129], v210 offset:0
    ds_read_b64_tr_b16 v[130:131], v210 offset:4128
    ds_read_b64_tr_b16 v[132:133], v210 offset:8256
    ds_read_b64_tr_b16 v[134:135], v210 offset:12384
    ds_read_b64_tr_b16 v[136:137], v210 offset:16512
    ds_read_b64_tr_b16 v[138:139], v210 offset:20640
    ds_read_b64_tr_b16 v[140:141], v210 offset:24768
    ds_read_b64_tr_b16 v[142:143], v210 offset:28896
    ds_read_b64_tr_b16 v[144:145], v210 offset:8
    ds_read_b64_tr_b16 v[146:147], v210 offset:4136
    ds_read_b64_tr_b16 v[148:149], v210 offset:8264
    ds_read_b64_tr_b16 v[150:151], v210 offset:12392
    ds_read_b64_tr_b16 v[152:153], v210 offset:16520
    ds_read_b64_tr_b16 v[154:155], v210 offset:20648
    ds_read_b64_tr_b16 v[156:157], v210 offset:24776
    ds_read_b64_tr_b16 v[158:159], v210 offset:28904
    v_and_b32 v2, 63, v0
    v_mfma_f32_16x16x32_bf16 v[64:67], v[212:215], v[48:51], 0
    v_mfma_f32_16x16x32_bf16 v[68:71], v[228:231], v[48:51], 0
    v_mfma_f32_16x16x32_bf16 v[64:67], v[216:219], v[52:55], v[64:67]
    v_mfma_f32_16x16x32_bf16 v[68:71], v[232:235], v[52:55], v[68:71]
    v_mfma_f32_16x16x32_bf16 v[64:67], v[220:223], v[56:59], v[64:67]
    v_mfma_f32_16x16x32_bf16 v[68:71], v[236:239], v[56:59], v[68:71]
    v_mfma_f32_16x16x32_bf16 v[64:67], v[224:227], v[60:63], v[64:67]
    v_mfma_f32_16x16x32_bf16 v[68:71], v[240:243], v[60:63], v[68:71]
    s_waitcnt lgkmcnt(15)
    v_mfma_f32_16x16x32_bf16 v[72:75], v[96:99], v[48:51], 0
    v_mfma_f32_16x16x32_bf16 v[76:79], v[112:115], v[48:51], 0
    v_mfma_f32_16x16x32_bf16 v[72:75], v[100:103], v[52:55], v[72:75]
    v_mfma_f32_16x16x32_bf16 v[76:79], v[116:119], v[52:55], v[76:79]
    v_mfma_f32_16x16x32_bf16 v[72:75], v[104:107], v[56:59], v[72:75]
    v_mfma_f32_16x16x32_bf16 v[76:79], v[120:123], v[56:59], v[76:79]
    v_mfma_f32_16x16x32_bf16 v[72:75], v[108:111], v[60:63], v[72:75]
    v_mfma_f32_16x16x32_bf16 v[76:79], v[124:127], v[60:63], v[76:79]
    ds_read_b64_tr_b16 v[96:97], v211 offset:0
    ds_read_b64_tr_b16 v[98:99], v211 offset:4128
    ds_read_b64_tr_b16 v[100:101], v211 offset:8256
    ds_read_b64_tr_b16 v[102:103], v211 offset:12384
    ds_read_b64_tr_b16 v[104:105], v211 offset:16512
    ds_read_b64_tr_b16 v[106:107], v211 offset:20640
    ds_read_b64_tr_b16 v[108:109], v211 offset:24768
    ds_read_b64_tr_b16 v[110:111], v211 offset:28896
    ds_read_b64_tr_b16 v[112:113], v211 offset:8
    ds_read_b64_tr_b16 v[114:115], v211 offset:4136
    ds_read_b64_tr_b16 v[116:117], v211 offset:8264
    ds_read_b64_tr_b16 v[118:119], v211 offset:12392
    ds_read_b64_tr_b16 v[120:121], v211 offset:16520
    ds_read_b64_tr_b16 v[122:123], v211 offset:20648
    ds_read_b64_tr_b16 v[124:125], v211 offset:24776
    ds_read_b64_tr_b16 v[126:127], v211 offset:28904
    s_waitcnt lgkmcnt(15)
    v_mfma_f32_16x16x32_bf16 v[80:83], v[128:131], v[48:51], 0
    v_mfma_f32_16x16x32_bf16 v[84:87], v[144:147], v[48:51], 0
    v_mfma_f32_16x16x32_bf16 v[80:83], v[132:135], v[52:55], v[80:83]
    v_mfma_f32_16x16x32_bf16 v[84:87], v[148:151], v[52:55], v[84:87]
    v_mfma_f32_16x16x32_bf16 v[80:83], v[136:139], v[56:59], v[80:83]
    v_mfma_f32_16x16x32_bf16 v[84:87], v[152:155], v[56:59], v[84:87]
    v_mfma_f32_16x16x32_bf16 v[80:83], v[140:143], v[60:63], v[80:83]
    v_mfma_f32_16x16x32_bf16 v[84:87], v[156:159], v[60:63], v[84:87]
    s_waitcnt lgkmcnt(0)
    v_mfma_f32_16x16x32_bf16 v[88:91], v[96:99], v[48:51], 0
    v_mfma_f32_16x16x32_bf16 v[92:95], v[112:115], v[48:51], 0
    v_mfma_f32_16x16x32_bf16 v[88:91], v[100:103], v[52:55], v[88:91]
    v_mfma_f32_16x16x32_bf16 v[92:95], v[116:119], v[52:55], v[92:95]
    v_mfma_f32_16x16x32_bf16 v[88:91], v[104:107], v[56:59], v[88:91]
    v_mfma_f32_16x16x32_bf16 v[92:95], v[120:123], v[56:59], v[92:95]
    v_mfma_f32_16x16x32_bf16 v[88:91], v[108:111], v[60:63], v[88:91]
    v_mfma_f32_16x16x32_bf16 v[92:95], v[124:127], v[60:63], v[92:95]
    v_lshl_add_u32 v2, v2, 4, s5
    s_cmp_lt_u32 s3, 2
    s_cselect_b32 s85, -1, 0xffff
    s_mov_b32 s84, -1
    s_nop 4
    v_cvt_pk_bf16_f32 v24, v64, v65
    v_cvt_pk_bf16_f32 v25, v66, v67
    v_cvt_pk_bf16_f32 v26, v68, v69
    v_cvt_pk_bf16_f32 v27, v70, v71
    ds_write_b128 v180, v[24:27]
    v_cvt_pk_bf16_f32 v28, v72, v73
    v_cvt_pk_bf16_f32 v29, v74, v75
    v_cvt_pk_bf16_f32 v30, v76, v77
    v_cvt_pk_bf16_f32 v31, v78, v79
    ds_write_b128 v181, v[28:31]
    v_cvt_pk_bf16_f32 v32, v80, v81
    v_cvt_pk_bf16_f32 v33, v82, v83
    v_cvt_pk_bf16_f32 v34, v84, v85
    v_cvt_pk_bf16_f32 v35, v86, v87
    ds_write_b128 v182, v[32:35]
    v_cvt_pk_bf16_f32 v36, v88, v89
    v_cvt_pk_bf16_f32 v37, v90, v91
    v_cvt_pk_bf16_f32 v38, v92, v93
    v_cvt_pk_bf16_f32 v39, v94, v95
    ds_write_b128 v183, v[36:39]
    s_waitcnt lgkmcnt(0)
    ds_read_b128 v[96:99], v2 offset:0
    ds_read_b128 v[100:103], v2 offset:1024
    ds_read_b128 v[104:107], v2 offset:2048
    ds_read_b128 v[108:111], v2 offset:3072
    s_mov_b64 exec, s[84:85]
    s_waitcnt lgkmcnt(3)
    buffer_store_dwordx4 v[96:99], v204, s[16:19], 0 offen nt
    s_mov_b32 exec_hi, 0xffff
    s_waitcnt lgkmcnt(2)
    buffer_store_dwordx4 v[100:103], v205, s[16:19], 0 offen nt
    s_waitcnt lgkmcnt(1)
    buffer_store_dwordx4 v[104:107], v206, s[16:19], 0 offen nt
    s_waitcnt lgkmcnt(0)
    buffer_store_dwordx4 v[108:111], v207, s[16:19], 0 offen nt
    s_cmp_ge_u32 s2, 128
    s_cbranch_scc1 K_noep
    s_cmp_lg_u32 s3, 0
    s_cbranch_scc1 K_noep
    s_mov_b64 exec, 1
    v_mov_b32 v1, s58
    buffer_store_dword v1, off, s[12:15], s89
K_noep:
K_end:
    s_endpgm
.section .rodata,"a"
.p2align 6
.amdhsa_kernel standalone__kernel_systems_refs_featgraph__graph_kernel
  .amdhsa_next_free_vgpr 248
  .amdhsa_next_free_sgpr 96
  .amdhsa_accum_offset 248
  .amdhsa_group_segment_fixed_size 0
  .amdhsa_kernarg_size 64
  .amdhsa_user_sgpr_count 2
  .amdhsa_user_sgpr_kernarg_segment_ptr 1
  .amdhsa_system_sgpr_workgroup_id_x 1
.end_amdhsa_kernel
```
